```python
import torch

def _softmax(x, axis=-1):
    return torch.softmax(x, dim=axis)
def _gelu(x):
    return torch.nn.functional.gelu(x, approximate="tanh")
def _silu(x):
    return torch.nn.functional.silu(x)
def _sigmoid(x):
    return torch.sigmoid(x)
def _layernorm(x, axis=-1, eps=1e-5):
    m = x.mean(dim=axis, keepdim=True)
    v = x.var(dim=axis, keepdim=True, unbiased=False)
    return (x - m) / torch.sqrt(v + eps)
def _scatter_add(tgt, idx, src, axis=0):
    return tgt.clone().index_add_(axis, idx, src)
def _segment_sum(src, seg, n):
    out = torch.zeros((n,) + src.shape[1:], dtype=src.dtype)
    return out.index_add_(0, seg, src)
def _pad(x, pw):
    flat = tuple(v for pair in reversed(pw) for v in pair)
    return torch.nn.functional.pad(x, flat)

kernel_name = 'recurrent_scan__gqa_block_cached__glu_gated_geglu__decode'

def setup_inputs():

    _w = (lambda a: (lambda t: t.to(torch.bfloat16) if t.is_floating_point() else t)(torch.as_tensor(a)))
    def _A_setup():
        B, Sq, D = 2, 1, 512
        Hq, Hkv, Sk, Dh = 32, 8, 32768, 128
        assert Hq % Hkv == 0, (Hq, Hkv)
        return {
            "x": _w((lambda *s: torch.randn(*s, dtype=torch.bfloat16) * 0.4)(B, Sq, D)),
            "k_cache": _w((lambda *s: torch.randn(*s, dtype=torch.bfloat16) * 1.6)(B, Hkv, Sk, Dh)),
            "v_cache": _w((lambda *s: torch.randn(*s, dtype=torch.bfloat16) * 1.6)(B, Hkv, Sk, Dh)),
            "wq": _w((lambda *s: torch.randn(*s, dtype=torch.bfloat16) * 1.6)(D, Hq * Dh) * (D ** -0.5)),
            "wo": _w((lambda *s: torch.randn(*s, dtype=torch.bfloat16) * 1.6)(Hq * Dh, D) * ((Hq * Dh) ** -0.5)),
        }
    _A_in = _A_setup()

    def _B_setup():
        B, S, Dm, Df = 2, 1, 512, 1792
        return {
            "x": _w((lambda *s: torch.randn(*s, dtype=torch.bfloat16) * 0.4)(B, S, Dm)),
            "w_gate": _w((lambda *s: torch.randn(*s, dtype=torch.bfloat16) * 1.6)(Dm, Df) * (Dm ** -0.5)),
            "w_up": _w((lambda *s: torch.randn(*s, dtype=torch.bfloat16) * 1.6)(Dm, Df) * (Dm ** -0.5)),
            "w_down": _w((lambda *s: torch.randn(*s, dtype=torch.bfloat16) * 1.6)(Df, Dm) * (Df ** -0.5)),
        }
    _B_in = _B_setup()

    return {
        "A_x": _A_in["x"],
        "A_k_cache": _A_in["k_cache"],
        "A_v_cache": _A_in["v_cache"],
        "A_wq": _A_in["wq"],
        "A_wo": _A_in["wo"],
        "B_x": _B_in["x"],
        "B_w_gate": _B_in["w_gate"],
        "B_w_up": _B_in["w_up"],
        "B_w_down": _B_in["w_down"],
    }

def reference(A_x, A_k_cache, A_v_cache, A_wq, A_wo, B_x, B_w_gate, B_w_up, B_w_down):
    def _A_ref(x, k_cache, v_cache, wq, wo):
        B, Sq, D = x.shape
        Hq, Dh = 32, 128
        Hkv = k_cache.shape[1]
        rep = Hq // Hkv
        q = (lambda x, *d: x.permute(*d))((x @ wq).reshape(B, Sq, Hq, Dh), 0, 2, 1, 3)
        k = (lambda x, n, axis: torch.repeat_interleave(x, n, dim=axis))(k_cache, rep, axis=1)
        v = (lambda x, n, axis: torch.repeat_interleave(x, n, dim=axis))(v_cache, rep, axis=1)
        scores = torch.einsum("bhqd,bhkd->bhqk", q, k) * (Dh ** -0.5)
        p = _softmax(scores, axis=-1)
        o = torch.einsum("bhqk,bhkd->bhqd", p, v)
        return (lambda x, *d: x.permute(*d))(o, 0, 2, 1, 3).reshape(B, Sq, Hq * Dh) @ wo

    def _B_ref(x, w_gate, w_up, w_down):
        g = torch.einsum("bsd,df->bsf", x, w_gate)
        u = torch.einsum("bsd,df->bsf", x, w_up)
        h = _gelu(g) * u
        return torch.einsum("bsf,fd->bsd", h, w_down)

    x = A_x
    xn = _layernorm(x, axis=-1)
    s = _A_ref(xn, A_k_cache, A_v_cache, A_wq, A_wo)
    g = _silu(_B_ref(xn, B_w_gate, B_w_up, B_w_down))
    return x + s * g
```

```asm
; @launch grid=(256,1,1) block=(384,1,1) lds=163392
.amdgcn_target "amdgcn-amd-amdhsa--gfx950"
.text
.globl recurrent_scan__gqa_block_cached__glu_gated_geglu__decode_kernel
.p2align 8
.type recurrent_scan__gqa_block_cached__glu_gated_geglu__decode_kernel,@function
recurrent_scan__gqa_block_cached__glu_gated_geglu__decode_kernel:
  s_cmp_ge_u32 s2, 256
  s_cbranch_scc1 L_end
  s_load_dwordx16 s[4:19], s[0:1], 0
  s_load_dwordx8 s[20:27], s[0:1], 64
  v_lshrrev_b32 v1, 6, v0
  v_and_b32 v0, 63, v0
  v_readfirstlane_b32 s3, v1
  s_lshr_b32 s40, s2, 4
  s_and_b32 s41, s40, 7
  s_lshr_b32 s42, s40, 3
  s_and_b32 s43, s2, 15
  v_lshrrev_b32 v2, 4, v0
  v_and_b32 v3, 15, v0
  s_and_b32 s44, s2, 7
  s_lshr_b32 s45, s2, 5
  s_add_u32 s45, s45, s44
  s_and_b32 s45, s45, 7
  s_lshl_b32 s45, s45, 2
  s_bfe_u32 s46, s2, 0x20003
  s_or_b32 s45, s45, s46
  s_cmp_eq_u32 s3, 1
  s_cbranch_scc1 L_aux
  s_cmp_gt_u32 s3, 1
  s_cbranch_scc1 L_cons
  s_setprio 2
  v_lshlrev_b32 v4, 1, v2
  v_xor_b32 v4, v4, v3
  v_lshlrev_b32 v4, 4, v4
  v_lshl_add_u32 v4, v2, 8, v4
  v_xor_b32 v5, 0x80, v4
  s_lshl_b32 s48, s40, 23
  s_mov_b32 s30, 0x800000
  s_mov_b32 s31, 0x20000
  s_lshl_b32 s47, s44, 20
  s_bfe_u32 s49, s2, 0x10003
  s_lshl_b32 s49, s49, 16
  s_add_u32 s47, s47, s49
  s_mov_b32 s64, s47
  s_mov_b32 s60, 0
  s_mov_b32 s55, 0
  s_mov_b32 s63, 0
  s_movk_i32 s61, 56
  s_mov_b32 s54, 0
  s_mov_b32 s70, 0
  s_mov_b32 s71, 0
  s_mov_b32 s72, 0
  s_mov_b32 s73, 0
  v_mov_b32 v25, 163328
  v_mov_b32 v28, 0
  v_mov_b32 v29, 0
  v_mov_b32 v30, 0
  v_mov_b32 v31, 0
  ds_write_b128 v25, v[28:31] offset:16
  ds_write_b128 v25, v[28:31] offset:32
  v_mov_b32 v32, 0
  v_mov_b32 v33, 0
  v_mov_b32 v34, -1
  v_mov_b32 v35, 0
  ds_write_b128 v25, v[32:35]
  s_lshl_b32 s50, s40, 8
  s_add_u32 s50, s50, 1310720
  v_mov_b32 v18, s50
  v_mov_b32 v19, 1
  v_mov_b32 v20, 0
  s_waitcnt lgkmcnt(0)
  s_add_u32 s32, s6, s48
  s_addc_u32 s33, s7, 0
  s_add_u32 s34, s8, s48
  s_addc_u32 s35, s9, 0
  s_mov_b64 s[28:29], s[32:33]
L_st:
  s_and_b32 s50, s60, 3
  s_lshl_b32 s51, s50, 2
  v_add_u32 v24, s51, v25
  ds_read_b32 v26, v24 offset:32
  s_lshr_b32 s62, s60, 2
  s_add_u32 s62, s62, s63
  s_lshl_b32 s66, s60, 3
  s_add_u32 s66, s66, 8
  s_or_b32 s66, s66, s55
  s_cmp_lg_u32 s66, 32
  s_cbranch_scc1 L_st_nb
  s_barrier
L_st_nb:
  s_call_b64 s[74:75], L_chk
  s_and_b32 s51, s70, 4
  v_add_u32 v22, s51, v25
  s_lshr_b32 s51, s70, 3
  v_mov_b32 v27, s51
  s_mov_b32 s70, s71
  s_mov_b32 s71, s72
  s_mov_b32 s72, s73
  s_mov_b64 exec, 1
  s_waitcnt vmcnt(17)
  ds_max_u32 v22, v27
  s_mov_b64 exec, -1
  s_call_b64 s[74:75], L_issue
  s_add_u32 s47, s47, 8192
  s_and_b32 s68, s47, 65535
  s_cselect_b32 s68, 0, 65536
  s_add_u32 s47, s47, s68
  s_cmp_eq_u32 s66, 412
  s_cbranch_scc1 L_st_t0
  s_cmp_lg_u32 s66, 428
  s_cbranch_scc1 L_st_next
  s_mov_b32 s52, 1
  s_branch L_st_t
L_st_t0:
  s_mov_b32 s57, 1000000
L_ld_flag:
  ds_read_b32 v26, v25 offset:12
  s_waitcnt lgkmcnt(0)
  v_readfirstlane_b32 s56, v26
  s_nop 0
  s_cmp_lg_u32 s56, 0
  s_cbranch_scc1 L_ld_flag_done
  s_sub_u32 s57, s57, 1
  s_cmp_lg_u32 s57, 0
  s_cbranch_scc1 L_ld_flag
L_ld_flag_done:
  s_mov_b32 s52, 0
L_st_t:
  s_lshl_b32 exec_lo, 1, s52
  s_mov_b32 exec_hi, 0
  global_atomic_add v20, v18, v19, s[26:27] sc0 sc1
  s_mov_b64 exec, -1
L_st_next:
  s_add_u32 s60, s60, 1
  s_cmp_lt_u32 s60, s61
  s_cbranch_scc1 L_st
  s_cmp_lg_u32 s55, 0
  s_cbranch_scc1 L_st_done
  s_mov_b64 s[28:29], s[34:35]
  s_mov_b32 s47, s64
  s_mov_b32 s60, 0
  s_mov_b32 s55, 4
  s_movk_i32 s63, 14
  s_movk_i32 s61, 54
  s_branch L_st
L_st_done:
  s_mov_b32 s46, s47
  s_add_u32 s47, s47, 8192
  s_and_b32 s68, s47, 65535
  s_cselect_b32 s68, 0, 65536
  s_add_u32 s47, s47, s68
  s_mov_b32 s65, s47
  s_movk_i32 s60, 56
L_pl:
  s_and_b32 s50, s60, 3
  s_lshl_b32 s51, s50, 2
  v_add_u32 v24, s51, v25
  ds_read_b32 v26, v24 offset:32
  s_lshr_b32 s62, s60, 2
  s_lshl_b32 s62, s62, 1
  s_lshl_b32 s66, s60, 3
  s_add_u32 s66, s66, 8
  s_mov_b64 s[28:29], s[32:33]
  s_call_b64 s[74:75], L_chk
  s_and_b32 s51, s70, 4
  v_add_u32 v22, s51, v25
  s_lshr_b32 s51, s70, 3
  v_mov_b32 v27, s51
  s_mov_b32 s70, s71
  s_mov_b32 s71, s72
  s_mov_b32 s72, s73
  s_mov_b64 exec, 1
  s_waitcnt vmcnt(17)
  ds_max_u32 v22, v27
  s_mov_b64 exec, -1
  v_readlane_b32 s56, v20, s50
  s_nop 0
  s_sub_u32 s68, s56, 896
  s_lshr_b32 s69, s68, 4
  s_and_b32 s68, s68, 15
  s_lshl_b32 s69, s69, 7
  s_add_u32 s68, s68, s69
  s_add_u32 s68, s68, 112
  s_lshl_b32 s47, s68, 13
  s_cmp_lt_u32 s56, 1024
  s_cbranch_scc1 L_pl_k
  s_mov_b32 s54, 1
  v_mov_b32 v30, s60
  ds_write_b32 v25, v30 offset:8
  s_branch L_pl_v
L_pl_k:
  s_call_b64 s[74:75], L_issue
  s_mov_b32 s67, s47
  s_xor_b32 s52, s50, 2
  s_lshl_b32 exec_lo, 1, s52
  s_mov_b32 exec_hi, 0
  global_atomic_add v20, v18, v19, s[26:27] sc0 sc1
  s_mov_b64 exec, -1
L_pl_v:
  s_sub_u32 s53, s60, 2
  s_and_b32 s50, s53, 3
  s_lshl_b32 s51, s50, 2
  v_add_u32 v24, s51, v25
  ds_read_b32 v26, v24 offset:32
  s_lshr_b32 s62, s53, 2
  s_lshl_b32 s62, s62, 1
  s_add_u32 s62, s62, 1
  s_lshl_b32 s66, s53, 3
  s_add_u32 s66, s66, 12
  s_mov_b64 s[28:29], s[34:35]
  s_mov_b32 s47, s46
  s_call_b64 s[74:75], L_chk
  s_cmp_eq_u32 s54, 1
  s_cbranch_scc1 L_pl_nowait
  s_and_b32 s51, s70, 4
  v_add_u32 v22, s51, v25
  s_lshr_b32 s51, s70, 3
  v_mov_b32 v27, s51
  s_mov_b32 s70, s71
  s_mov_b32 s71, s72
  s_mov_b32 s72, s73
  s_mov_b64 exec, 1
  s_waitcnt vmcnt(17)
  ds_max_u32 v22, v27
  s_mov_b64 exec, -1
L_pl_nowait:
  s_call_b64 s[74:75], L_issue
  s_mov_b32 s46, s65
  s_mov_b32 s65, s67
  s_add_u32 s60, s60, 1
  s_cmp_eq_u32 s54, 0
  s_cbranch_scc1 L_pl
  s_add_u32 s54, s54, 1
  s_cmp_eq_u32 s54, 2
  s_cbranch_scc1 L_pl_v
  s_mov_b64 exec, 1
  s_and_b32 s51, s70, 4
  v_add_u32 v22, s51, v25
  s_lshr_b32 s51, s70, 3
  v_mov_b32 v27, s51
  s_waitcnt vmcnt(24)
  ds_max_u32 v22, v27
  s_and_b32 s51, s71, 4
  v_add_u32 v22, s51, v25
  s_lshr_b32 s51, s71, 3
  v_mov_b32 v27, s51
  s_waitcnt vmcnt(16)
  ds_max_u32 v22, v27
  s_and_b32 s51, s72, 4
  v_add_u32 v22, s51, v25
  s_lshr_b32 s51, s72, 3
  v_mov_b32 v27, s51
  s_waitcnt vmcnt(8)
  ds_max_u32 v22, v27
  s_and_b32 s51, s73, 4
  v_add_u32 v22, s51, v25
  s_lshr_b32 s51, s73, 3
  v_mov_b32 v27, s51
  s_waitcnt vmcnt(0)
  ds_max_u32 v22, v27
  s_waitcnt lgkmcnt(0)
  s_endpgm
L_chk:
  s_and_b32 s51, s62, 3
  s_lshl_b32 s51, s51, 13
  s_lshl_b32 s44, s50, 15
  s_add_u32 s44, s44, s51
  s_sub_i32 s62, s62, 3
  s_waitcnt lgkmcnt(0)
  v_readfirstlane_b32 s56, v26
  s_nop 0
  s_cmp_ge_i32 s56, s62
  s_cbranch_scc1 L_is_free
  s_waitcnt vmcnt(0)
  s_and_b32 s51, s70, 4
  v_add_u32 v22, s51, v25
  s_lshr_b32 s51, s70, 3
  v_mov_b32 v27, s51
  ds_max_u32 v22, v27
  s_and_b32 s51, s71, 4
  v_add_u32 v22, s51, v25
  s_lshr_b32 s51, s71, 3
  v_mov_b32 v27, s51
  ds_max_u32 v22, v27
  s_and_b32 s51, s72, 4
  v_add_u32 v22, s51, v25
  s_lshr_b32 s51, s72, 3
  v_mov_b32 v27, s51
  ds_max_u32 v22, v27
  s_and_b32 s51, s73, 4
  v_add_u32 v22, s51, v25
  s_lshr_b32 s51, s73, 3
  v_mov_b32 v27, s51
  ds_max_u32 v22, v27
  s_mov_b32 s57, 1000000
L_is_spin:
  ds_read_b32 v26, v24 offset:32
  s_waitcnt lgkmcnt(0)
  v_readfirstlane_b32 s56, v26
  s_nop 0
  s_cmp_ge_i32 s56, s62
  s_cbranch_scc1 L_is_free
  s_sub_u32 s57, s57, 1
  s_cmp_lg_u32 s57, 0
  s_cbranch_scc1 L_is_spin
L_is_free:
  s_mov_b32 m0, s44
  s_setpc_b64 s[74:75]
L_issue:
  buffer_load_dwordx4 v4, s[28:31], s47 offen offset:0 nt lds
  buffer_load_dwordx4 v5, s[28:31], s47 offen offset:1024 nt lds
  buffer_load_dwordx4 v4, s[28:31], s47 offen offset:2048 nt lds
  buffer_load_dwordx4 v5, s[28:31], s47 offen offset:3072 nt lds
  s_add_u32 m0, s44, 4096
  s_add_u32 s49, s47, 4096
  buffer_load_dwordx4 v4, s[28:31], s49 offen offset:0 nt lds
  buffer_load_dwordx4 v5, s[28:31], s49 offen offset:1024 nt lds
  buffer_load_dwordx4 v4, s[28:31], s49 offen offset:2048 nt lds
  buffer_load_dwordx4 v5, s[28:31], s49 offen offset:3072 nt lds
  s_mov_b32 s73, s66
  s_setpc_b64 s[74:75]
L_cons:
  s_sub_u32 s3, s3, 2
  v_lshrrev_b32 v23, 3, v0
  v_lshlrev_b32 v23, 13, v23
  v_and_b32 v24, 7, v0
  v_lshl_add_u32 v23, v24, 4, v23
  s_lshl_b32 s49, s44, 10
  s_lshr_b32 s50, s45, 2
  s_lshl_b32 s50, s50, 7
  s_add_u32 s49, s49, s50
  s_lshl_b32 s50, s46, 20
  s_add_u32 s49, s49, s50
  s_lshl_b32 s50, s3, 18
  s_add_u32 s49, s49, s50
  s_lshl_b32 s50, s3, 12
  s_add_u32 s50, s50, 131072
  s_mov_b32 s38, 0x400000
  s_mov_b32 s39, 0x20000
  s_lshl_b32 s44, s3, 15
  s_waitcnt lgkmcnt(0)
  s_mov_b32 s36, s10
  s_mov_b32 s37, s11
  s_add_u32 m0, s50, 0
  s_nop 0
  buffer_load_dwordx4 v23, s[36:39], s49 offen nt lds
  s_add_u32 m0, s50, 1024
  s_add_u32 s49, s49, 65536
  buffer_load_dwordx4 v23, s[36:39], s49 offen nt lds
  s_add_u32 m0, s50, 2048
  s_add_u32 s49, s49, 65536
  buffer_load_dwordx4 v23, s[36:39], s49 offen nt lds
  s_add_u32 m0, s50, 3072
  s_add_u32 s49, s49, 65536
  buffer_load_dwordx4 v23, s[36:39], s49 offen nt lds
  s_and_b32 s58, s2, 7
  s_lshl_b32 s48, s58, 16
  s_lshl_b32 s49, s45, 11
  s_add_u32 s48, s48, s49
  s_lshl_b32 s49, s3, 10
  s_add_u32 s48, s48, s49
  s_add_u32 s48, s48, 131072
  s_bfe_u32 s49, s2, 0x10003
  s_lshl_b32 s47, s42, 1
  s_or_b32 s49, s49, s47
  s_lshl_b32 s47, s41, 2
  s_add_u32 s47, s47, s49
  s_lshl_b32 s49, s58, 5
  s_add_u32 s49, s49, s47
  s_lshl_b32 s49, s49, 10
  s_add_u32 s49, s49, 720896
  s_cmp_eq_u32 s3, 2
  s_cselect_b32 s48, s49, s48
  s_lshr_b32 s49, s45, 3
  s_lshl_b32 s50, s58, 2
  s_add_u32 s49, s49, s50
  s_lshl_b32 s49, s49, 2
  s_add_u32 s49, s49, s46
  s_lshl_b32 s49, s49, 10
  s_bfe_u32 s50, s45, 0x10002
  s_lshl_b32 s50, s50, 9
  s_add_u32 s49, s49, s50
  s_add_u32 s49, s49, 1048576
  s_cmp_eq_u32 s3, 3
  s_cselect_b32 s48, s49, s48
  v_lshl_add_u32 v23, v0, 4, s48
  v_mov_b32 v28, -1
  v_mov_b32 v29, -1
  v_mov_b32 v30, -1
  v_mov_b32 v31, -1
  s_cbranch_scc0 L_clr
  s_lshl_b32 s48, s45, 3
  s_add_u32 s48, s48, s58
  s_lshl_b32 s48, s48, 8
  s_add_u32 s48, s48, 1310720
  v_writelane_b32 v23, s48, 32
  s_movk_i32 s48, 896
  v_writelane_b32 v28, s48, 32
  s_mov_b32 exec_hi, 1
L_clr:
  global_store_dwordx4 v23, v[28:31], s[26:27] sc1
  s_mov_b64 exec, -1
  s_barrier
  v_and_b32 v23, 7, v3
  v_lshlrev_b32 v23, 1, v23
  v_xor_b32 v23, v23, v2
  v_lshlrev_b32 v23, 4, v23
  v_lshl_add_u32 v23, v3, 8, v23
  v_add_u32 v6, s44, v23
  v_xor_b32 v7, 64, v6
  v_xor_b32 v8, 0x80, v6
  v_xor_b32 v9, 0xc0, v6
  v_lshrrev_b32 v23, 2, v0
  v_and_b32 v24, 7, v23
  v_lshlrev_b32 v24, 5, v24
  v_lshl_add_u32 v24, v23, 8, v24
  v_and_b32 v25, 3, v0
  v_lshl_add_u32 v24, v25, 3, v24
  v_add_u32 v10, s44, v24
  v_xor_b32 v11, 32, v10
  v_xor_b32 v12, 64, v10
  v_xor_b32 v13, 96, v10
  v_xor_b32 v14, 128, v10
  v_xor_b32 v15, 160, v10
  v_xor_b32 v16, 192, v10
  v_xor_b32 v17, 224, v10
  v_mov_b32 v19, 1
  v_mov_b32 v21, 0xff800000
  v_mov_b32 v22, 0
  v_mov_b32 v25, 163328
  s_mov_b32 s51, 0x3db504f3
  s_mov_b32 s52, 0x3fb8aa3b
  s_mov_b32 s53, 0xffff0000
  s_lshl_b32 s50, s3, 2
  v_add_u32 v18, s50, v25
  v_mov_b32 v20, 0
  s_waitcnt vmcnt(0)
  ds_write_b32 v18, v19 offset:16
  v_mov_b64 v[96:97], 0
  v_mov_b64 v[98:99], 0
  v_mov_b64 v[100:101], 0
  v_mov_b64 v[102:103], 0
  v_mov_b64 v[104:105], 0
  v_mov_b64 v[106:107], 0
  v_mov_b64 v[108:109], 0
  v_mov_b64 v[110:111], 0
  v_mov_b64 v[112:113], 0
  v_mov_b64 v[114:115], 0
  v_mov_b64 v[116:117], 0
  v_mov_b64 v[118:119], 0
  v_mov_b64 v[120:121], 0
  v_mov_b64 v[122:123], 0
  v_mov_b64 v[124:125], 0
  v_mov_b64 v[126:127], 0
  v_lshlrev_b32 v1, 9, v3
  v_lshl_add_u32 v1, v2, 4, v1
  v_add_u32 v1, s44, v1
  v_lshlrev_b32 v4, 3, v3
  v_add_u32 v4, s44, v4
  v_and_b32 v23, 31, v0
  v_lshlrev_b32 v23, 4, v23
  s_lshl_b32 s45, s3, 9
  v_add_u32 v5, s45, v23
  v_add_u32 v29, 0x10000, v5
  s_lshl_b32 s45, s3, 3
  v_mov_b32 v30, s45
  v_add_u32 v31, 0x10000, v30
  s_lshl_b32 s45, s41, 2
  s_add_u32 s45, s45, s3
  s_lshl_b32 s45, s45, 1
  s_add_u32 s45, s45, s42
  s_lshl_b32 s45, s45, 4
  s_add_u32 s45, s45, s43
  s_lshl_b32 s46, s45, 9
  s_add_u32 s46, s46, 131072
  v_add_u32 v92, s46, v23
  s_mov_b32 s72, 0x07060500
  s_mov_b32 s73, 0x07060501
  s_mov_b32 s74, 0x07060502
  s_mov_b32 s75, 0x07060503
  s_mov_b32 s76, 0x0c0c0400
  s_mov_b32 s77, 0x04000c0c
  s_mov_b64 s[28:29], 1
  s_mov_b32 s30, 0x000f000f
  s_mov_b32 s31, 0x000f000f
  s_mov_b64 s[32:33], -1
  s_mov_b32 s34, -1
  s_mov_b32 s35, 0
  s_bfe_u32 s46, s2, 0x10003
  s_lshl_b32 s47, s42, 1
  s_or_b32 s46, s46, s47
  s_lshl_b32 s47, s41, 2
  s_add_u32 s47, s47, s46
  v_lshrrev_b32 v23, 5, v0
  v_bfe_u32 v24, v0, 3, 2
  v_and_b32 v26, 7, v0
  v_lshlrev_b32 v93, 13, v23
  v_lshl_add_u32 v93, v24, 9, v93
  v_lshl_add_u32 v93, v26, 4, v93
  s_lshl_b32 s45, s47, 14
  s_lshl_b32 s46, s3, 7
  s_add_u32 s45, s45, s46
  s_add_u32 s45, s45, 135168
  v_add_u32 v93, s45, v93
  v_lshlrev_b32 v95, 8, v23
  v_lshl_add_u32 v95, v26, 3, v95
  v_and_b32 v24, 1, v2
  v_lshl_add_u32 v95, v24, 2, v95
  s_lshl_b32 s45, s3, 6
  s_add_u32 s45, s45, 162816
  v_add_u32 v95, s45, v95
  s_mov_b32 s60, s3
  s_mov_b32 s61, 0
  s_mov_b32 s62, 0
  s_mov_b32 s63, 0
  v_and_b32 v23, 3, v0
  v_lshlrev_b32 v94, 6, v23
  v_lshl_add_u32 v94, v2, 4, v94
  v_add_u32 v94, 147456, v94
  s_and_b32 s48, s61, 3
  s_lshl_b32 s48, s48, 13
  s_xor_b32 s49, s48, s62
  s_mov_b32 s62, s48
  s_add_u32 s61, s61, 1
  v_xor_b32 v6, s49, v6
  v_xor_b32 v7, s49, v7
  v_xor_b32 v8, s49, v8
  v_xor_b32 v9, s49, v9
  s_mov_b32 s57, 1000000
L_wl0:
  ds_read_b96 v[26:28], v25
  s_waitcnt lgkmcnt(0)
  v_readfirstlane_b32 s56, v26
  v_readfirstlane_b32 s59, v28
  s_cmp_gt_u32 s56, s60
  s_cbranch_scc1 L_wl0_done
  s_sub_u32 s57, s57, 1
  s_cmp_lg_u32 s57, 0
  s_sleep 1
  s_cbranch_scc1 L_wl0
L_wl0_done:
  ds_read_b128 v[128:131], v6 offset:0
  ds_read_b128 v[144:147], v6 offset:4096
  ds_read_b128 v[132:135], v7 offset:0
  ds_read_b128 v[148:151], v7 offset:4096
  ds_read_b128 v[136:139], v8 offset:0
  ds_read_b128 v[152:155], v8 offset:4096
  ds_read_b128 v[140:143], v9 offset:0
  ds_read_b128 v[156:159], v9 offset:4096
  s_add_u32 s60, s60, 4
  v_mov_b32 v20, s61
  s_waitcnt lgkmcnt(0)
  ds_write_b32 v18, v20 offset:32
  s_and_b32 s48, s61, 3
  s_lshl_b32 s48, s48, 13
  s_xor_b32 s49, s48, s62
  s_mov_b32 s62, s48
  s_add_u32 s61, s61, 1
  v_xor_b32 v6, s49, v6
  v_xor_b32 v7, s49, v7
  v_xor_b32 v8, s49, v8
  v_xor_b32 v9, s49, v9
  s_mov_b32 s57, 1000000
L_wl1:
  ds_read_b96 v[26:28], v25
  s_waitcnt lgkmcnt(0)
  v_readfirstlane_b32 s56, v26
  v_readfirstlane_b32 s59, v28
  s_cmp_gt_u32 s56, s60
  s_cbranch_scc1 L_wl1_done
  s_sub_u32 s57, s57, 1
  s_cmp_lg_u32 s57, 0
  s_sleep 1
  s_cbranch_scc1 L_wl1
L_wl1_done:
  ds_read_b128 v[160:163], v6 offset:0
  ds_read_b128 v[176:179], v6 offset:4096
  ds_read_b128 v[164:167], v7 offset:0
  ds_read_b128 v[180:183], v7 offset:4096
  ds_read_b128 v[168:171], v8 offset:0
  ds_read_b128 v[184:187], v8 offset:4096
  ds_read_b128 v[172:175], v9 offset:0
  ds_read_b128 v[188:191], v9 offset:4096
  s_add_u32 s60, s60, 4
  v_mov_b32 v20, s61
  s_waitcnt lgkmcnt(0)
  ds_write_b32 v18, v20 offset:32
  s_and_b32 s48, s61, 3
  s_lshl_b32 s48, s48, 13
  s_xor_b32 s49, s48, s62
  s_mov_b32 s62, s48
  s_add_u32 s61, s61, 1
  v_xor_b32 v6, s49, v6
  v_xor_b32 v7, s49, v7
  v_xor_b32 v8, s49, v8
  v_xor_b32 v9, s49, v9
  s_mov_b32 s57, 1000000
L_wl2:
  ds_read_b96 v[26:28], v25
  s_waitcnt lgkmcnt(0)
  v_readfirstlane_b32 s56, v26
  v_readfirstlane_b32 s59, v28
  s_cmp_gt_u32 s56, s60
  s_cbranch_scc1 L_wl2_done
  s_sub_u32 s57, s57, 1
  s_cmp_lg_u32 s57, 0
  s_sleep 1
  s_cbranch_scc1 L_wl2
L_wl2_done:
  ds_read_b128 v[192:195], v6 offset:0
  ds_read_b128 v[208:211], v6 offset:4096
  ds_read_b128 v[196:199], v7 offset:0
  ds_read_b128 v[212:215], v7 offset:4096
  ds_read_b128 v[200:203], v8 offset:0
  ds_read_b128 v[216:219], v8 offset:4096
  ds_read_b128 v[204:207], v9 offset:0
  ds_read_b128 v[220:223], v9 offset:4096
  s_add_u32 s60, s60, 4
  v_mov_b32 v20, s61
  s_waitcnt lgkmcnt(0)
  ds_write_b32 v18, v20 offset:32
  s_and_b32 s48, s61, 3
  s_lshl_b32 s48, s48, 13
  s_xor_b32 s49, s48, s62
  s_mov_b32 s62, s48
  s_add_u32 s61, s61, 1
  v_xor_b32 v6, s49, v6
  v_xor_b32 v7, s49, v7
  v_xor_b32 v8, s49, v8
  v_xor_b32 v9, s49, v9
  s_mov_b32 s57, 1000000
L_wl3:
  ds_read_b96 v[26:28], v25
  s_waitcnt lgkmcnt(0)
  v_readfirstlane_b32 s56, v26
  v_readfirstlane_b32 s59, v28
  s_cmp_gt_u32 s56, s60
  s_cbranch_scc1 L_wl3_done
  s_sub_u32 s57, s57, 1
  s_cmp_lg_u32 s57, 0
  s_sleep 1
  s_cbranch_scc1 L_wl3
L_wl3_done:
  ds_read_b128 v[224:227], v6 offset:0
  ds_read_b128 v[240:243], v6 offset:4096
  ds_read_b128 v[228:231], v7 offset:0
  ds_read_b128 v[244:247], v7 offset:4096
  ds_read_b128 v[232:235], v8 offset:0
  ds_read_b128 v[248:251], v8 offset:4096
  ds_read_b128 v[236:239], v9 offset:0
  ds_read_b128 v[252:255], v9 offset:4096
  s_add_u32 s60, s60, 4
  v_mov_b32 v20, s61
  s_waitcnt lgkmcnt(0)
  ds_write_b32 v18, v20 offset:32
  v_lshlrev_b32 v23, 8, v23
  v_lshl_add_u32 v23, v2, 4, v23
  v_add_u32 v23, 161792, v23
  s_mov_b32 s57, 1000000
L_qflag:
  ds_read_b32 v26, v25 offset:12
  s_waitcnt lgkmcnt(0)
  v_readfirstlane_b32 s56, v26
  s_nop 0
  s_cmp_lg_u32 s56, 0
  s_cbranch_scc1 L_qflag_done
  s_sub_u32 s57, s57, 1
  s_cmp_lg_u32 s57, 0
  s_sleep 1
  s_cbranch_scc1 L_qflag
L_qflag_done:
  ds_read_b128 v[32:35], v23 offset:0
  ds_read_b128 v[36:39], v23 offset:64
  ds_read_b128 v[40:43], v23 offset:128
  ds_read_b128 v[44:47], v23 offset:192
  s_mov_b32 s58, 0
  s_mov_b32 s59, -1
  s_mov_b32 s60, s3
  s_waitcnt lgkmcnt(0)
L_loop:
  s_lshl_b32 s48, s60, 8
  v_add_u32 v23, s48, v94
  s_cmp_eq_u32 s58, 5
  s_cbranch_scc1 L_sc
  s_cmp_ge_u32 s58, 4
  s_cbranch_scc1 L_kA
  s_cmp_lg_u32 s58, 0
  s_cbranch_scc1 L_kS1
  v_mov_b64 v[48:49], v[128:129]
  v_mov_b64 v[50:51], v[130:131]
  v_mov_b64 v[52:53], v[132:133]
  v_mov_b64 v[54:55], v[134:135]
  v_mov_b64 v[56:57], v[136:137]
  v_mov_b64 v[58:59], v[138:139]
  v_mov_b64 v[60:61], v[140:141]
  v_mov_b64 v[62:63], v[142:143]
  v_mov_b64 v[64:65], v[144:145]
  v_mov_b64 v[66:67], v[146:147]
  v_mov_b64 v[68:69], v[148:149]
  v_mov_b64 v[70:71], v[150:151]
  v_mov_b64 v[72:73], v[152:153]
  v_mov_b64 v[74:75], v[154:155]
  v_mov_b64 v[76:77], v[156:157]
  v_mov_b64 v[78:79], v[158:159]
  s_branch L_qk
L_kS1:
  s_cmp_lg_u32 s58, 1
  s_cbranch_scc1 L_kS2
  v_mov_b64 v[48:49], v[160:161]
  v_mov_b64 v[50:51], v[162:163]
  v_mov_b64 v[52:53], v[164:165]
  v_mov_b64 v[54:55], v[166:167]
  v_mov_b64 v[56:57], v[168:169]
  v_mov_b64 v[58:59], v[170:171]
  v_mov_b64 v[60:61], v[172:173]
  v_mov_b64 v[62:63], v[174:175]
  v_mov_b64 v[64:65], v[176:177]
  v_mov_b64 v[66:67], v[178:179]
  v_mov_b64 v[68:69], v[180:181]
  v_mov_b64 v[70:71], v[182:183]
  v_mov_b64 v[72:73], v[184:185]
  v_mov_b64 v[74:75], v[186:187]
  v_mov_b64 v[76:77], v[188:189]
  v_mov_b64 v[78:79], v[190:191]
  s_branch L_qk
L_kS2:
  s_cmp_lg_u32 s58, 2
  s_cbranch_scc1 L_kS3
  v_mov_b64 v[48:49], v[192:193]
  v_mov_b64 v[50:51], v[194:195]
  v_mov_b64 v[52:53], v[196:197]
  v_mov_b64 v[54:55], v[198:199]
  v_mov_b64 v[56:57], v[200:201]
  v_mov_b64 v[58:59], v[202:203]
  v_mov_b64 v[60:61], v[204:205]
  v_mov_b64 v[62:63], v[206:207]
  v_mov_b64 v[64:65], v[208:209]
  v_mov_b64 v[66:67], v[210:211]
  v_mov_b64 v[68:69], v[212:213]
  v_mov_b64 v[70:71], v[214:215]
  v_mov_b64 v[72:73], v[216:217]
  v_mov_b64 v[74:75], v[218:219]
  v_mov_b64 v[76:77], v[220:221]
  v_mov_b64 v[78:79], v[222:223]
  s_branch L_qk
L_kS3:
  v_mov_b64 v[48:49], v[224:225]
  v_mov_b64 v[50:51], v[226:227]
  v_mov_b64 v[52:53], v[228:229]
  v_mov_b64 v[54:55], v[230:231]
  v_mov_b64 v[56:57], v[232:233]
  v_mov_b64 v[58:59], v[234:235]
  v_mov_b64 v[60:61], v[236:237]
  v_mov_b64 v[62:63], v[238:239]
  v_mov_b64 v[64:65], v[240:241]
  v_mov_b64 v[66:67], v[242:243]
  v_mov_b64 v[68:69], v[244:245]
  v_mov_b64 v[70:71], v[246:247]
  v_mov_b64 v[72:73], v[248:249]
  v_mov_b64 v[74:75], v[250:251]
  v_mov_b64 v[76:77], v[252:253]
  v_mov_b64 v[78:79], v[254:255]
  s_branch L_qk
L_kA:
  s_and_b32 s48, s61, 3
  s_lshl_b32 s48, s48, 13
  s_xor_b32 s49, s48, s62
  s_mov_b32 s62, s48
  s_add_u32 s61, s61, 1
  v_xor_b32 v6, s49, v6
  v_xor_b32 v7, s49, v7
  v_xor_b32 v8, s49, v8
  v_xor_b32 v9, s49, v9
  s_mov_b32 s57, 1000000
L_wl4:
  ds_read_b96 v[26:28], v25
  s_waitcnt lgkmcnt(0)
  v_readfirstlane_b32 s56, v26
  v_readfirstlane_b32 s59, v28
  s_cmp_gt_u32 s56, s60
  s_cbranch_scc1 L_wl4_done
  s_cmp_ge_u32 s60, s59
  s_cbranch_scc1 L_fin
  s_sub_u32 s57, s57, 1
  s_cmp_lg_u32 s57, 0
  s_sleep 1
  s_cbranch_scc1 L_wl4
  s_branch L_fin
L_wl4_done:
  ds_read_b128 v[48:51], v6 offset:0
  ds_read_b128 v[64:67], v6 offset:4096
  ds_read_b128 v[52:55], v7 offset:0
  ds_read_b128 v[68:71], v7 offset:4096
  ds_read_b128 v[56:59], v8 offset:0
  ds_read_b128 v[72:75], v8 offset:4096
  ds_read_b128 v[60:63], v9 offset:0
  ds_read_b128 v[76:79], v9 offset:4096
  v_mov_b32 v20, s61
L_qk:
  s_nop 1
  s_waitcnt lgkmcnt(7)
  v_mfma_f32_16x16x32_bf16 v[80:83], v[48:51], v[32:35], 0
  s_waitcnt lgkmcnt(6)
  v_mfma_f32_16x16x32_bf16 v[84:87], v[64:67], v[32:35], 0
  s_waitcnt lgkmcnt(5)
  v_mfma_f32_16x16x32_bf16 v[80:83], v[52:55], v[36:39], v[80:83]
  s_waitcnt lgkmcnt(4)
  v_mfma_f32_16x16x32_bf16 v[84:87], v[68:71], v[36:39], v[84:87]
  s_waitcnt lgkmcnt(3)
  v_mfma_f32_16x16x32_bf16 v[80:83], v[56:59], v[40:43], v[80:83]
  s_waitcnt lgkmcnt(2)
  v_mfma_f32_16x16x32_bf16 v[84:87], v[72:75], v[40:43], v[84:87]
  s_waitcnt lgkmcnt(1)
  v_mfma_f32_16x16x32_bf16 v[80:83], v[60:63], v[44:47], v[80:83]
  s_waitcnt lgkmcnt(0)
  v_mfma_f32_16x16x32_bf16 v[84:87], v[76:79], v[44:47], v[84:87]
  ds_write_b32 v18, v20 offset:32
  s_nop 4
  v_cvt_pk_bf16_f32 v88, v80, v81
  v_cvt_pk_bf16_f32 v89, v82, v83
  v_cvt_pk_bf16_f32 v90, v84, v85
  v_cvt_pk_bf16_f32 v91, v86, v87
  v_lshlrev_b32 v80, 16, v88
  v_and_b32 v81, s53, v88
  v_lshlrev_b32 v82, 16, v89
  v_and_b32 v83, s53, v89
  v_lshlrev_b32 v84, 16, v90
  v_and_b32 v85, s53, v90
  v_lshlrev_b32 v86, 16, v91
  v_and_b32 v87, s53, v91
  v_mul_f32 v80, s51, v80
  v_mul_f32 v81, s51, v81
  v_mul_f32 v82, s51, v82
  v_mul_f32 v83, s51, v83
  v_mul_f32 v84, s51, v84
  v_mul_f32 v85, s51, v85
  v_mul_f32 v86, s51, v86
  v_mul_f32 v87, s51, v87
  v_cvt_pk_bf16_f32 v88, v80, v81
  v_cvt_pk_bf16_f32 v89, v82, v83
  v_cvt_pk_bf16_f32 v90, v84, v85
  v_cvt_pk_bf16_f32 v91, v86, v87
  s_cmp_eq_u32 s58, 6
  s_cbranch_scc1 L_un
  s_mov_b64 exec, s[30:31]
  ds_write_b128 v23, v[88:91]
  s_mov_b64 exec, -1
  s_cmp_lt_u32 s58, 4
  s_addc_u32 s58, s58, 0
  s_add_u32 s60, s60, 4
  s_cmp_lt_u32 s60, 56
  s_cbranch_scc1 L_loop
  s_mov_b32 s58, 5
  s_mov_b32 s60, s3
  s_branch L_loop
L_sc:
  ds_read_b128 v[88:91], v23
  s_waitcnt lgkmcnt(0)
L_un:
  v_lshlrev_b32 v80, 16, v88
  v_and_b32 v81, s53, v88
  v_lshlrev_b32 v82, 16, v89
  v_and_b32 v83, s53, v89
  v_lshlrev_b32 v84, 16, v90
  v_and_b32 v85, s53, v90
  v_lshlrev_b32 v86, 16, v91
  v_and_b32 v87, s53, v91
  v_max3_f32 v23, v80, v81, v82
  v_max3_f32 v24, v83, v84, v85
  v_max3_f32 v23, v23, v86, v87
  v_max3_f32 v23, v23, v24, v21
  v_mov_b32 v24, v23
  s_nop 1
  v_permlane16_swap_b32 v23, v24
  v_max_f32 v23, v23, v24
  v_mov_b32 v24, v23
  s_nop 1
  v_permlane32_swap_b32 v23, v24
  v_max_f32 v23, v23, v24
  v_cmp_neq_f32 vcc, v21, v23
  v_sub_f32 v24, v21, v23
  v_mov_b32 v21, v23
  v_mul_f32 v24, s52, v24
  v_sub_f32 v80, v80, v23
  v_sub_f32 v81, v81, v23
  v_sub_f32 v82, v82, v23
  v_sub_f32 v83, v83, v23
  v_sub_f32 v84, v84, v23
  v_sub_f32 v85, v85, v23
  v_sub_f32 v86, v86, v23
  v_sub_f32 v87, v87, v23
  v_mul_f32 v80, s52, v80
  v_mul_f32 v81, s52, v81
  v_mul_f32 v82, s52, v82
  v_mul_f32 v83, s52, v83
  v_mul_f32 v84, s52, v84
  v_mul_f32 v85, s52, v85
  v_mul_f32 v86, s52, v86
  v_mul_f32 v87, s52, v87
  v_exp_f32 v80, v80
  v_exp_f32 v81, v81
  v_exp_f32 v82, v82
  v_exp_f32 v83, v83
  v_exp_f32 v84, v84
  v_exp_f32 v85, v85
  v_exp_f32 v86, v86
  v_exp_f32 v87, v87
  s_cbranch_vccz L_norescale
  v_exp_f32 v24, v24
  s_nop 0
  v_mul_f32 v22, v22, v24
  v_mul_f32 v96, v96, v24
  v_mul_f32 v97, v97, v24
  v_mul_f32 v98, v98, v24
  v_mul_f32 v99, v99, v24
  v_mul_f32 v100, v100, v24
  v_mul_f32 v101, v101, v24
  v_mul_f32 v102, v102, v24
  v_mul_f32 v103, v103, v24
  v_mul_f32 v104, v104, v24
  v_mul_f32 v105, v105, v24
  v_mul_f32 v106, v106, v24
  v_mul_f32 v107, v107, v24
  v_mul_f32 v108, v108, v24
  v_mul_f32 v109, v109, v24
  v_mul_f32 v110, v110, v24
  v_mul_f32 v111, v111, v24
  v_mul_f32 v112, v112, v24
  v_mul_f32 v113, v113, v24
  v_mul_f32 v114, v114, v24
  v_mul_f32 v115, v115, v24
  v_mul_f32 v116, v116, v24
  v_mul_f32 v117, v117, v24
  v_mul_f32 v118, v118, v24
  v_mul_f32 v119, v119, v24
  v_mul_f32 v120, v120, v24
  v_mul_f32 v121, v121, v24
  v_mul_f32 v122, v122, v24
  v_mul_f32 v123, v123, v24
  v_mul_f32 v124, v124, v24
  v_mul_f32 v125, v125, v24
  v_mul_f32 v126, v126, v24
  v_mul_f32 v127, v127, v24
L_norescale:
  s_nop 0
  v_cvt_pk_bf16_f32 v88, v80, v81
  v_cvt_pk_bf16_f32 v89, v82, v83
  v_cvt_pk_bf16_f32 v90, v84, v85
  v_cvt_pk_bf16_f32 v91, v86, v87
  v_add_f32 v80, v80, v81
  v_add_f32 v82, v82, v83
  v_add_f32 v84, v84, v85
  v_add_f32 v86, v86, v87
  v_add_f32 v80, v80, v82
  v_add_f32 v84, v84, v86
  v_add_f32 v80, v80, v84
  v_add_f32 v22, v22, v80
  s_and_b32 s48, s61, 3
  s_lshl_b32 s48, s48, 13
  s_xor_b32 s49, s48, s63
  s_mov_b32 s63, s48
  s_add_u32 s61, s61, 1
  v_xor_b32 v10, s49, v10
  v_xor_b32 v11, s49, v11
  v_xor_b32 v12, s49, v12
  v_xor_b32 v13, s49, v13
  v_xor_b32 v14, s49, v14
  v_xor_b32 v15, s49, v15
  v_xor_b32 v16, s49, v16
  v_xor_b32 v17, s49, v17
  s_mov_b32 s57, 1000000
L_wl5:
  ds_read_b96 v[26:28], v25
  s_waitcnt lgkmcnt(0)
  v_readfirstlane_b32 s56, v27
  v_readfirstlane_b32 s59, v28
  s_cmp_gt_u32 s56, s60
  s_cbranch_scc1 L_wl5_done
  s_sub_u32 s57, s57, 1
  s_cmp_lg_u32 s57, 0
  s_cbranch_scc1 L_wl5
L_wl5_done:
  ds_read_b64_tr_b16 v[48:49], v10 offset:0
  ds_read_b64_tr_b16 v[50:51], v10 offset:4096
  ds_read_b64_tr_b16 v[52:53], v11 offset:0
  ds_read_b64_tr_b16 v[54:55], v11 offset:4096
  ds_read_b64_tr_b16 v[56:57], v12 offset:0
  ds_read_b64_tr_b16 v[58:59], v12 offset:4096
  ds_read_b64_tr_b16 v[60:61], v13 offset:0
  ds_read_b64_tr_b16 v[62:63], v13 offset:4096
  ds_read_b64_tr_b16 v[64:65], v14 offset:0
  ds_read_b64_tr_b16 v[66:67], v14 offset:4096
  ds_read_b64_tr_b16 v[68:69], v15 offset:0
  ds_read_b64_tr_b16 v[70:71], v15 offset:4096
  ds_read_b64_tr_b16 v[72:73], v16 offset:0
  ds_read_b64_tr_b16 v[74:75], v16 offset:4096
  ds_read_b64_tr_b16 v[76:77], v17 offset:0
  ds_read_b64_tr_b16 v[78:79], v17 offset:4096
  v_mov_b32 v20, s61
  s_add_u32 s60, s60, 4
  s_cmp_ge_u32 s60, 56
  s_cselect_b32 s58, 6, s58
  s_waitcnt lgkmcnt(14)
  v_mfma_f32_16x16x32_bf16 v[96:99], v[48:51], v[88:91], v[96:99]
  s_waitcnt lgkmcnt(12)
  v_mfma_f32_16x16x32_bf16 v[100:103], v[52:55], v[88:91], v[100:103]
  s_waitcnt lgkmcnt(10)
  v_mfma_f32_16x16x32_bf16 v[104:107], v[56:59], v[88:91], v[104:107]
  s_waitcnt lgkmcnt(8)
  v_mfma_f32_16x16x32_bf16 v[108:111], v[60:63], v[88:91], v[108:111]
  s_waitcnt lgkmcnt(6)
  v_mfma_f32_16x16x32_bf16 v[112:115], v[64:67], v[88:91], v[112:115]
  s_waitcnt lgkmcnt(4)
  v_mfma_f32_16x16x32_bf16 v[116:119], v[68:71], v[88:91], v[116:119]
  s_waitcnt lgkmcnt(2)
  v_mfma_f32_16x16x32_bf16 v[120:123], v[72:75], v[88:91], v[120:123]
  s_waitcnt lgkmcnt(0)
  v_mfma_f32_16x16x32_bf16 v[124:127], v[76:79], v[88:91], v[124:127]
  ds_write_b32 v18, v20 offset:32
  s_cmp_lt_u32 s60, s59
  s_cbranch_scc1 L_loop
L_fin:
  v_mov_b32 v24, v22
  v_mov_b32 v26, v21
  s_nop 0
  v_permlane16_swap_b32 v22, v24
  v_add_f32 v22, v22, v24
  v_mov_b32 v24, v22
  s_nop 1
  v_permlane32_swap_b32 v22, v24
  v_add_f32 v27, v22, v24
  s_mov_b64 exec, s[30:31]
  ds_write_b64 v4, v[26:27] offset:18432
  ds_write_b128 v1, v[96:99] offset:16384
  ds_write_b128 v1, v[100:103] offset:16448
  ds_write_b128 v1, v[104:107] offset:16512
  ds_write_b128 v1, v[108:111] offset:16576
  ds_write_b128 v1, v[112:115] offset:16640
  ds_write_b128 v1, v[116:119] offset:16704
  ds_write_b128 v1, v[120:123] offset:16768
  ds_write_b128 v1, v[124:127] offset:16832
  s_mov_b64 exec, s[32:33]
  s_waitcnt lgkmcnt(0)
  s_cbranch_execz L_nb2
  s_barrier
L_nb2:
  ds_read_b64 v[32:33], v30 offset:18432
  ds_read_b64 v[34:35], v30 offset:51200
  ds_read_b64 v[36:37], v31 offset:18432
  ds_read_b64 v[38:39], v31 offset:51200
  ds_read_b128 v[48:51], v5 offset:16384
  ds_read_b128 v[52:55], v5 offset:49152
  ds_read_b128 v[56:59], v29 offset:16384
  ds_read_b128 v[60:63], v29 offset:49152
  s_waitcnt lgkmcnt(4)
  v_max3_f32 v40, v32, v34, v36
  v_max_f32 v40, v40, v38
  v_sub_f32 v32, v32, v40
  v_sub_f32 v34, v34, v40
  v_sub_f32 v36, v36, v40
  v_sub_f32 v38, v38, v40
  v_mul_f32 v32, s52, v32
  v_mul_f32 v34, s52, v34
  v_mul_f32 v36, s52, v36
  v_mul_f32 v38, s52, v38
  v_exp_f32 v32, v32
  v_exp_f32 v34, v34
  v_exp_f32 v36, v36
  v_exp_f32 v38, v38
  v_mul_f32 v41, v32, v33
  v_fmac_f32 v41, v34, v35
  v_fmac_f32 v41, v36, v37
  v_fmac_f32 v41, v38, v39
  v_rcp_f32 v42, v41
  v_log_f32 v41, v41
  s_waitcnt lgkmcnt(0)
  v_mul_f32 v48, v32, v48
  v_mul_f32 v49, v32, v49
  v_mul_f32 v50, v32, v50
  v_mul_f32 v51, v32, v51
  v_fmac_f32 v41, s52, v40
  v_fmac_f32 v48, v34, v52
  v_fmac_f32 v49, v34, v53
  v_fmac_f32 v50, v34, v54
  v_fmac_f32 v51, v34, v55
  v_fmac_f32 v48, v36, v56
  v_fmac_f32 v49, v36, v57
  v_fmac_f32 v50, v36, v58
  v_fmac_f32 v51, v36, v59
  v_fmac_f32 v48, v38, v60
  v_fmac_f32 v49, v38, v61
  v_fmac_f32 v50, v38, v62
  v_fmac_f32 v51, v38, v63
  v_mul_f32 v48, v42, v48
  v_mul_f32 v49, v42, v49
  v_mul_f32 v50, v42, v50
  v_mul_f32 v51, v42, v51
  v_perm_b32 v48, v48, v41, s72
  v_perm_b32 v49, v49, v41, s73
  v_perm_b32 v50, v50, v41, s74
  v_perm_b32 v51, v51, v41, s75
  v_min_u32 v48, -2, v48
  v_min_u32 v49, -2, v49
  v_min_u32 v50, -2, v50
  v_min_u32 v51, -2, v51
  s_mov_b64 exec, s[34:35]
  s_cbranch_execz L_nopub
  global_store_dwordx4 v92, v[48:51], s[26:27] sc1
L_nopub:
  s_waitcnt vmcnt(0)
  s_mov_b64 s[64:65], s[32:33]
  s_mov_b64 s[66:67], s[32:33]
  s_mov_b64 s[68:69], s[32:33]
  s_mov_b64 s[70:71], s[32:33]
  s_mov_b32 s57, 50000
L_p_poll:
  s_mov_b64 exec, s[64:65]
  s_cbranch_execz L_p_skip0
  global_load_dwordx4 v[64:67], v93, s[26:27] offset:-4096 sc1
L_p_skip0:
  s_mov_b64 exec, s[66:67]
  s_cbranch_execz L_p_skip1
  global_load_dwordx4 v[68:71], v93, s[26:27] offset:-2048 sc1
L_p_skip1:
  s_mov_b64 exec, s[68:69]
  s_cbranch_execz L_p_skip2
  global_load_dwordx4 v[72:75], v93, s[26:27] offset:0 sc1
L_p_skip2:
  s_mov_b64 exec, s[70:71]
  s_cbranch_execz L_p_skip3
  global_load_dwordx4 v[76:79], v93, s[26:27] offset:2048 sc1
L_p_skip3:
  s_mov_b64 exec, s[32:33]
  s_waitcnt vmcnt(0)
  v_max3_u32 v32, v64, v65, v66
  v_max3_u32 v33, v68, v69, v70
  v_max3_u32 v34, v72, v73, v74
  v_max3_u32 v35, v76, v77, v78
  v_max_u32 v32, v32, v67
  v_max_u32 v33, v33, v71
  v_max_u32 v34, v34, v75
  v_max_u32 v35, v35, v79
  v_cmp_eq_u32 s[64:65], -1, v32
  v_cmp_eq_u32 s[66:67], -1, v33
  v_cmp_eq_u32 s[68:69], -1, v34
  v_cmp_eq_u32 s[70:71], -1, v35
  v_perm_b32 v80, v65, v64, s76
  v_perm_b32 v84, v67, v66, s77
  v_perm_b32 v81, v69, v68, s76
  v_perm_b32 v85, v71, v70, s77
  v_perm_b32 v82, v73, v72, s76
  v_perm_b32 v86, v75, v74, s77
  v_perm_b32 v83, v77, v76, s76
  v_perm_b32 v87, v79, v78, s77
  s_or_b64 s[50:51], s[64:65], s[66:67]
  s_or_b64 s[48:49], s[68:69], s[70:71]
  s_or_b64 s[50:51], s[50:51], s[48:49]
  s_cbranch_scc0 L_p_done
  s_sub_u32 s57, s57, 1
  s_cmp_eq_u32 s57, 0
  s_cbranch_scc1 L_p_done
  s_branch L_p_poll
L_p_done:
  v_or_b32 v80, v80, v84
  v_or_b32 v81, v81, v85
  v_or_b32 v82, v82, v86
  v_or_b32 v83, v83, v87
  v_max3_f32 v40, v80, v81, v82
  v_max_f32 v40, v40, v83
  s_nop 1
  v_max_f32_dpp v40, v40, v40 row_ror:8 row_mask:0xf bank_mask:0xf
  v_mov_b32 v41, v40
  s_nop 1
  v_permlane16_swap_b32 v40, v41
  v_max_f32 v40, v40, v41
  v_sub_f32 v32, v80, v40
  v_sub_f32 v33, v81, v40
  v_sub_f32 v34, v82, v40
  v_sub_f32 v35, v83, v40
  v_exp_f32 v32, v32
  v_exp_f32 v33, v33
  v_exp_f32 v34, v34
  v_exp_f32 v35, v35
  v_mul_f32 v36, v32, v64
  v_mul_f32 v37, v32, v65
  v_mul_f32 v38, v32, v66
  v_mul_f32 v39, v32, v67
  v_add_f32 v44, v32, v33
  v_add_f32 v45, v34, v35
  v_fmac_f32 v36, v33, v68
  v_fmac_f32 v37, v33, v69
  v_fmac_f32 v38, v33, v70
  v_fmac_f32 v39, v33, v71
  v_add_f32 v44, v44, v45
  v_fmac_f32 v36, v34, v72
  v_fmac_f32 v37, v34, v73
  v_fmac_f32 v38, v34, v74
  v_fmac_f32 v39, v34, v75
  v_mov_b32 v45, v44
  v_fmac_f32 v36, v35, v76
  v_fmac_f32 v37, v35, v77
  v_fmac_f32 v38, v35, v78
  v_fmac_f32 v39, v35, v79
  v_permlane16_swap_b32 v44, v45
  v_permlane16_swap_b32 v36, v38
  v_permlane16_swap_b32 v37, v39
  v_add_f32 v44, v44, v45
  v_add_f32 v36, v36, v38
  v_add_f32 v37, v37, v39
  v_add_f32_dpp v44, v44, v44 row_ror:8 row_mask:0xf bank_mask:0xf
  v_add_f32_dpp v36, v36, v36 row_ror:8 row_mask:0xf bank_mask:0xf
  v_add_f32_dpp v37, v37, v37 row_ror:8 row_mask:0xf bank_mask:0xf
  v_rcp_f32 v44, v44
  s_nop 0
  v_mul_f32 v36, v36, v44
  v_mul_f32 v37, v37, v44
  v_cvt_pk_bf16_f32 v36, v36, v37
  ds_write_b32 v95, v36
  s_waitcnt lgkmcnt(0)
  s_cbranch_execz L_dry_aux
  s_barrier
  s_endpgm
L_aux:
  s_setprio 3
  v_mov_b32 v5, 163328
  v_lshlrev_b32 v1, 4, v0
  v_mov_b32 v4, 0
  s_waitcnt lgkmcnt(0)
  global_load_dwordx4 v[16:19], v1, s[4:5]
  global_load_dwordx4 v[20:23], v1, s[4:5] offset:1024
  global_load_dwordx2 v[24:25], v4, s[26:27]
  s_barrier
  s_and_b32 s46, s45, 1
  s_lshl_b32 s47, s42, 1
  s_or_b32 s46, s46, s47
  s_lshl_b32 s47, s41, 2
  s_add_u32 s47, s47, s46
  v_and_b32 v6, 1, v0
  s_mov_b32 s39, 0x20000
  s_mov_b32 s52, 0x3fb8aa3b
  s_mov_b32 s53, 0xffff0000
  s_waitcnt vmcnt(1)
  v_lshlrev_b32 v32, 16, v16
  v_and_b32 v33, s53, v16
  v_lshlrev_b32 v34, 16, v17
  v_and_b32 v35, s53, v17
  v_lshlrev_b32 v36, 16, v18
  v_and_b32 v37, s53, v18
  v_lshlrev_b32 v38, 16, v19
  v_and_b32 v39, s53, v19
  v_lshlrev_b32 v40, 16, v20
  v_and_b32 v41, s53, v20
  v_lshlrev_b32 v42, 16, v21
  v_and_b32 v43, s53, v21
  v_lshlrev_b32 v44, 16, v22
  v_and_b32 v45, s53, v22
  v_lshlrev_b32 v46, 16, v23
  v_and_b32 v47, s53, v23
  v_add_f32 v48, v32, v33
  v_add_f32 v49, v34, v35
  v_add_f32 v50, v36, v37
  v_add_f32 v51, v38, v39
  v_add_f32 v48, v48, v49
  v_add_f32 v50, v50, v51
  v_add_f32 v26, v48, v50
  v_add_f32 v52, v40, v41
  v_add_f32 v53, v42, v43
  v_add_f32 v54, v44, v45
  v_add_f32 v55, v46, v47
  v_add_f32 v52, v52, v53
  v_add_f32 v54, v54, v55
  v_add_f32 v27, v52, v54
  v_add_f32_dpp v26, v26, v26 row_ror:8 row_mask:0xf bank_mask:0xf
  s_nop 0
  v_add_f32_dpp v27, v27, v27 row_ror:8 row_mask:0xf bank_mask:0xf
  v_add_f32_dpp v26, v26, v26 row_ror:4 row_mask:0xf bank_mask:0xf
  s_nop 0
  v_add_f32_dpp v27, v27, v27 row_ror:4 row_mask:0xf bank_mask:0xf
  v_add_f32_dpp v26, v26, v26 row_ror:2 row_mask:0xf bank_mask:0xf
  s_nop 0
  v_add_f32_dpp v27, v27, v27 row_ror:2 row_mask:0xf bank_mask:0xf
  v_add_f32_dpp v26, v26, v26 row_ror:1 row_mask:0xf bank_mask:0xf
  s_nop 0
  v_add_f32_dpp v27, v27, v27 row_ror:1 row_mask:0xf bank_mask:0xf
  v_mov_b32 v28, v26
  v_mov_b32 v29, v27
  s_nop 0
  v_permlane16_swap_b32 v26, v28
  v_permlane16_swap_b32 v27, v29
  v_add_f32 v26, v26, v28
  v_add_f32 v27, v27, v29
  v_mov_b32 v28, v26
  v_mov_b32 v29, v27
  s_nop 0
  v_permlane32_swap_b32 v26, v28
  v_permlane32_swap_b32 v27, v29
  v_add_f32 v26, v26, v28
  v_add_f32 v27, v27, v29
  s_mov_b32 s48, 0x3b000000
  v_mul_f32 v26, s48, v26
  v_mul_f32 v27, s48, v27
  v_sub_f32 v48, v32, v26
  v_sub_f32 v49, v33, v26
  v_sub_f32 v50, v34, v26
  v_sub_f32 v51, v35, v26
  v_sub_f32 v52, v36, v26
  v_sub_f32 v53, v37, v26
  v_sub_f32 v54, v38, v26
  v_sub_f32 v55, v39, v26
  v_sub_f32 v56, v40, v27
  v_sub_f32 v57, v41, v27
  v_sub_f32 v58, v42, v27
  v_sub_f32 v59, v43, v27
  v_sub_f32 v60, v44, v27
  v_sub_f32 v61, v45, v27
  v_sub_f32 v62, v46, v27
  v_sub_f32 v63, v47, v27
  v_mul_f32 v28, v48, v48
  v_mul_f32 v29, v56, v56
  v_fmac_f32 v28, v49, v49
  v_fmac_f32 v29, v57, v57
  v_fmac_f32 v28, v50, v50
  v_fmac_f32 v29, v58, v58
  v_fmac_f32 v28, v51, v51
  v_fmac_f32 v29, v59, v59
  v_fmac_f32 v28, v52, v52
  v_fmac_f32 v29, v60, v60
  v_fmac_f32 v28, v53, v53
  v_fmac_f32 v29, v61, v61
  v_fmac_f32 v28, v54, v54
  v_fmac_f32 v29, v62, v62
  v_fmac_f32 v28, v55, v55
  v_fmac_f32 v29, v63, v63
  s_nop 0
  v_add_f32_dpp v28, v28, v28 row_ror:8 row_mask:0xf bank_mask:0xf
  v_add_f32_dpp v29, v29, v29 row_ror:8 row_mask:0xf bank_mask:0xf
  s_nop 0
  v_add_f32_dpp v28, v28, v28 row_ror:4 row_mask:0xf bank_mask:0xf
  v_add_f32_dpp v29, v29, v29 row_ror:4 row_mask:0xf bank_mask:0xf
  s_nop 0
  v_add_f32_dpp v28, v28, v28 row_ror:2 row_mask:0xf bank_mask:0xf
  v_add_f32_dpp v29, v29, v29 row_ror:2 row_mask:0xf bank_mask:0xf
  s_nop 0
  v_add_f32_dpp v28, v28, v28 row_ror:1 row_mask:0xf bank_mask:0xf
  v_add_f32_dpp v29, v29, v29 row_ror:1 row_mask:0xf bank_mask:0xf
  v_mov_b32 v30, v28
  v_mov_b32 v31, v29
  s_nop 0
  v_permlane16_swap_b32 v28, v30
  v_permlane16_swap_b32 v29, v31
  v_add_f32 v28, v28, v30
  v_add_f32 v29, v29, v31
  v_mov_b32 v30, v28
  v_mov_b32 v31, v29
  s_nop 0
  v_permlane32_swap_b32 v28, v30
  v_permlane32_swap_b32 v29, v31
  v_add_f32 v28, v28, v30
  v_add_f32 v29, v29, v31
  v_mul_f32 v28, s48, v28
  v_mul_f32 v29, s48, v29
  v_cvt_pk_bf16_f32 v30, v26, v27
  v_cvt_pk_bf16_f32 v31, v28, v29
  v_lshlrev_b32 v26, 16, v30
  v_and_b32 v27, s53, v30
  v_lshlrev_b32 v28, 16, v31
  v_and_b32 v29, s53, v31
  v_add_f32 v28, 0x3727c5ac, v28
  v_add_f32 v29, 0x3727c5ac, v29
  v_cvt_pk_bf16_f32 v31, v28, v29
  v_lshlrev_b32 v28, 16, v31
  v_and_b32 v29, s53, v31
  v_sqrt_f32 v28, v28
  v_sqrt_f32 v29, v29
  v_sub_f32 v32, v32, v26
  v_sub_f32 v33, v33, v26
  v_sub_f32 v34, v34, v26
  v_sub_f32 v35, v35, v26
  v_sub_f32 v36, v36, v26
  v_sub_f32 v37, v37, v26
  v_sub_f32 v38, v38, v26
  v_sub_f32 v39, v39, v26
  v_sub_f32 v40, v40, v27
  v_sub_f32 v41, v41, v27
  v_sub_f32 v42, v42, v27
  v_sub_f32 v43, v43, v27
  v_sub_f32 v44, v44, v27
  v_sub_f32 v45, v45, v27
  v_sub_f32 v46, v46, v27
  v_sub_f32 v47, v47, v27
  v_cvt_pk_bf16_f32 v31, v28, v29
  v_lshlrev_b32 v28, 16, v31
  v_and_b32 v29, s53, v31
  v_rcp_f32 v30, v28
  v_rcp_f32 v31, v29
  v_cvt_pk_bf16_f32 v48, v32, v33
  v_cvt_pk_bf16_f32 v49, v34, v35
  v_cvt_pk_bf16_f32 v50, v36, v37
  v_cvt_pk_bf16_f32 v51, v38, v39
  v_cvt_pk_bf16_f32 v52, v40, v41
  v_cvt_pk_bf16_f32 v53, v42, v43
  v_cvt_pk_bf16_f32 v54, v44, v45
  v_cvt_pk_bf16_f32 v55, v46, v47
  v_lshlrev_b32 v32, 16, v48
  v_and_b32 v33, s53, v48
  v_lshlrev_b32 v34, 16, v49
  v_and_b32 v35, s53, v49
  v_lshlrev_b32 v36, 16, v50
  v_and_b32 v37, s53, v50
  v_lshlrev_b32 v38, 16, v51
  v_and_b32 v39, s53, v51
  v_lshlrev_b32 v40, 16, v52
  v_and_b32 v41, s53, v52
  v_lshlrev_b32 v42, 16, v53
  v_and_b32 v43, s53, v53
  v_lshlrev_b32 v44, 16, v54
  v_and_b32 v45, s53, v54
  v_lshlrev_b32 v46, 16, v55
  v_and_b32 v47, s53, v55
  v_mul_f32 v48, v32, v30
  v_mul_f32 v49, v33, v30
  v_mul_f32 v50, v34, v30
  v_mul_f32 v51, v35, v30
  v_mul_f32 v52, v36, v30
  v_mul_f32 v53, v37, v30
  v_mul_f32 v54, v38, v30
  v_mul_f32 v55, v39, v30
  v_mul_f32 v56, v40, v31
  v_mul_f32 v57, v41, v31
  v_mul_f32 v58, v42, v31
  v_mul_f32 v59, v43, v31
  v_mul_f32 v60, v44, v31
  v_mul_f32 v61, v45, v31
  v_mul_f32 v62, v46, v31
  v_mul_f32 v63, v47, v31
  v_fma_f32 v32, -v48, v28, v32
  v_fma_f32 v33, -v49, v28, v33
  v_fma_f32 v34, -v50, v28, v34
  v_fma_f32 v35, -v51, v28, v35
  v_fma_f32 v36, -v52, v28, v36
  v_fma_f32 v37, -v53, v28, v37
  v_fma_f32 v38, -v54, v28, v38
  v_fma_f32 v39, -v55, v28, v39
  v_fma_f32 v40, -v56, v29, v40
  v_fma_f32 v41, -v57, v29, v41
  v_fma_f32 v42, -v58, v29, v42
  v_fma_f32 v43, -v59, v29, v43
  v_fma_f32 v44, -v60, v29, v44
  v_fma_f32 v45, -v61, v29, v45
  v_fma_f32 v46, -v62, v29, v46
  v_fma_f32 v47, -v63, v29, v47
  v_fmac_f32 v48, v32, v30
  v_fmac_f32 v49, v33, v30
  v_fmac_f32 v50, v34, v30
  v_fmac_f32 v51, v35, v30
  v_fmac_f32 v52, v36, v30
  v_fmac_f32 v53, v37, v30
  v_fmac_f32 v54, v38, v30
  v_fmac_f32 v55, v39, v30
  v_fmac_f32 v56, v40, v31
  v_fmac_f32 v57, v41, v31
  v_fmac_f32 v58, v42, v31
  v_fmac_f32 v59, v43, v31
  v_fmac_f32 v60, v44, v31
  v_fmac_f32 v61, v45, v31
  v_fmac_f32 v62, v46, v31
  v_fmac_f32 v63, v47, v31
  v_cvt_pk_bf16_f32 v32, v48, v49
  v_cvt_pk_bf16_f32 v33, v50, v51
  v_cvt_pk_bf16_f32 v34, v52, v53
  v_cvt_pk_bf16_f32 v35, v54, v55
  v_cvt_pk_bf16_f32 v36, v56, v57
  v_cvt_pk_bf16_f32 v37, v58, v59
  v_cvt_pk_bf16_f32 v38, v60, v61
  v_cvt_pk_bf16_f32 v39, v62, v63
  v_add_u32 v7, 155648, v1
  ds_write_b128 v7, v[32:35]
  ds_write_b128 v7, v[36:39] offset:1024
  v_lshlrev_b32 v7, 10, v6
  v_lshl_add_u32 v7, v2, 3, v7
  v_add_u32 v7, 155648, v7
  s_and_b32 s59, s45, 3
  s_lshr_b32 s60, s45, 2
  s_lshl_b32 s48, s59, 8
  v_add_u32 v8, s48, v7
  v_lshrrev_b32 v13, 2, v0
  v_lshlrev_b32 v13, 7, v13
  v_and_b32 v14, 3, v0
  v_lshl_add_u32 v13, v14, 3, v13
  v_add_u32 v14, 147456, v13
  v_add_u32 v13, 131072, v13
  s_waitcnt lgkmcnt(0)
  ds_read2_b64 v[32:35], v8 offset0:0 offset1:4
  ds_read2_b64 v[36:39], v8 offset0:8 offset1:12
  ds_read2_b64 v[40:43], v8 offset0:16 offset1:20
  ds_read2_b64 v[44:47], v8 offset0:24 offset1:28
  v_lshrrev_b32 v10, 1, v3
  v_and_b32 v10, 3, v10
  v_cmp_eq_u32 s[72:73], 1, v10
  v_cmp_eq_u32 s[74:75], 2, v10
  v_cmp_eq_u32 s[76:77], 3, v10
  v_cmp_lt_u32 s[78:79], 7, v3
  v_lshlrev_b32 v11, 6, v10
  v_lshl_add_u32 v11, v2, 4, v11
  s_lshl_b32 s48, s44, 2
  s_add_u32 s48, s48, s59
  s_lshl_b32 s48, s48, 12
  s_lshl_b32 s49, s60, 9
  s_add_u32 s48, s48, s49
  s_add_u32 s48, s48, 1572864
  v_lshlrev_b32 v9, 17, v6
  v_lshl_add_u32 v9, v11, 1, v9
  v_and_b32 v10, 8, v3
  v_lshl_add_u32 v9, v10, 1, v9
  v_add_u32 v9, s48, v9
  v_lshl_add_u32 v11, v6, 8, v11
  s_waitcnt vmcnt(0)
  v_add_u32 v24, 0x9e3779b9, v24
  v_add_u32 v25, 0x7f4a7c15, v25
  s_mov_b32 s57, 1000000
L_wqflag:
  ds_read_b128 v[28:31], v5 offset:16
  s_waitcnt lgkmcnt(0)
  v_and_b32 v28, v28, v29
  v_and_b32 v30, v30, v31
  v_and_b32 v28, v28, v30
  s_nop 0
  v_readfirstlane_b32 s56, v28
  s_nop 0
  s_cmp_lg_u32 s56, 0
  s_cbranch_scc1 L_wqflag_done
  s_sub_u32 s57, s57, 1
  s_cmp_lg_u32 s57, 0
  s_cbranch_scc1 L_wqflag
L_wqflag_done:
  ds_read_b64_tr_b16 v[128:129], v13 offset:0
  ds_read_b64_tr_b16 v[130:131], v13 offset:2048
  ds_read_b64_tr_b16 v[132:133], v13 offset:32
  ds_read_b64_tr_b16 v[134:135], v13 offset:2080
  ds_read_b64_tr_b16 v[136:137], v13 offset:64
  ds_read_b64_tr_b16 v[138:139], v13 offset:2112
  ds_read_b64_tr_b16 v[140:141], v13 offset:96
  ds_read_b64_tr_b16 v[142:143], v13 offset:2144
  ds_read_b64_tr_b16 v[144:145], v13 offset:4096
  ds_read_b64_tr_b16 v[146:147], v13 offset:6144
  ds_read_b64_tr_b16 v[148:149], v13 offset:4128
  ds_read_b64_tr_b16 v[150:151], v13 offset:6176
  ds_read_b64_tr_b16 v[152:153], v13 offset:4160
  ds_read_b64_tr_b16 v[154:155], v13 offset:6208
  ds_read_b64_tr_b16 v[156:157], v13 offset:4192
  ds_read_b64_tr_b16 v[158:159], v13 offset:6240
  ds_read_b64_tr_b16 v[160:161], v13 offset:8192
  ds_read_b64_tr_b16 v[162:163], v13 offset:10240
  ds_read_b64_tr_b16 v[164:165], v13 offset:8224
  ds_read_b64_tr_b16 v[166:167], v13 offset:10272
  ds_read_b64_tr_b16 v[168:169], v13 offset:8256
  ds_read_b64_tr_b16 v[170:171], v13 offset:10304
  ds_read_b64_tr_b16 v[172:173], v13 offset:8288
  ds_read_b64_tr_b16 v[174:175], v13 offset:10336
  ds_read_b64_tr_b16 v[176:177], v13 offset:12288
  ds_read_b64_tr_b16 v[178:179], v13 offset:14336
  ds_read_b64_tr_b16 v[180:181], v13 offset:12320
  ds_read_b64_tr_b16 v[182:183], v13 offset:14368
  ds_read_b64_tr_b16 v[184:185], v13 offset:12352
  ds_read_b64_tr_b16 v[186:187], v13 offset:14400
  ds_read_b64_tr_b16 v[188:189], v13 offset:12384
  ds_read_b64_tr_b16 v[190:191], v13 offset:14432
  s_waitcnt lgkmcnt(0)
  v_mfma_f32_16x16x32_bf16 v[48:51], v[128:131], v[32:35], 0
  v_mfma_f32_16x16x32_bf16 v[52:55], v[132:135], v[32:35], 0
  v_mfma_f32_16x16x32_bf16 v[56:59], v[136:139], v[32:35], 0
  v_mfma_f32_16x16x32_bf16 v[60:63], v[140:143], v[32:35], 0
  v_mfma_f32_16x16x32_bf16 v[48:51], v[144:147], v[36:39], v[48:51]
  v_mfma_f32_16x16x32_bf16 v[52:55], v[148:151], v[36:39], v[52:55]
  v_mfma_f32_16x16x32_bf16 v[56:59], v[152:155], v[36:39], v[56:59]
  v_mfma_f32_16x16x32_bf16 v[60:63], v[156:159], v[36:39], v[60:63]
  v_mfma_f32_16x16x32_bf16 v[48:51], v[160:163], v[40:43], v[48:51]
  v_mfma_f32_16x16x32_bf16 v[52:55], v[164:167], v[40:43], v[52:55]
  v_mfma_f32_16x16x32_bf16 v[56:59], v[168:171], v[40:43], v[56:59]
  v_mfma_f32_16x16x32_bf16 v[60:63], v[172:175], v[40:43], v[60:63]
  v_mfma_f32_16x16x32_bf16 v[48:51], v[176:179], v[44:47], v[48:51]
  v_mfma_f32_16x16x32_bf16 v[52:55], v[180:183], v[44:47], v[52:55]
  v_mfma_f32_16x16x32_bf16 v[56:59], v[184:187], v[44:47], v[56:59]
  v_mfma_f32_16x16x32_bf16 v[60:63], v[188:191], v[44:47], v[60:63]
  s_nop 5
  v_cndmask_b32 v48, v48, v52, s[72:73]
  v_cndmask_b32 v49, v49, v53, s[72:73]
  v_cndmask_b32 v50, v50, v54, s[72:73]
  v_cndmask_b32 v51, v51, v55, s[72:73]
  v_cndmask_b32 v48, v48, v56, s[74:75]
  v_cndmask_b32 v49, v49, v57, s[74:75]
  v_cndmask_b32 v50, v50, v58, s[74:75]
  v_cndmask_b32 v51, v51, v59, s[74:75]
  v_cndmask_b32 v48, v48, v60, s[76:77]
  v_cndmask_b32 v49, v49, v61, s[76:77]
  v_cndmask_b32 v50, v50, v62, s[76:77]
  v_cndmask_b32 v51, v51, v63, s[76:77]
  v_cndmask_b32 v52, v48, v50, s[78:79]
  v_mov_b32 v53, v24
  v_cndmask_b32 v54, v49, v51, s[78:79]
  v_mov_b32 v55, v25
  global_store_dwordx4 v9, v[52:55], s[26:27] sc1
  s_getreg_b32 s50, hwreg(HW_REG_XCC_ID, 0, 4)
  s_lshl_b32 s48, s44, 8
  s_lshl_b32 s49, s47, 3
  s_add_u32 s48, s48, s49
  s_add_u32 s48, s48, 8192
  v_mov_b32 v9, s48
  v_mov_b32 v20, v24
  v_and_b32 v21, 0xffffff00, v25
  v_or_b32 v21, s50, v21
  s_mov_b64 exec, 1
  global_store_dwordx2 v9, v[20:21], s[26:27] sc1
  s_mov_b64 exec, -1
  s_lshl_b32 s48, s44, 5
  s_add_u32 s48, s48, s47
  s_lshl_b32 s48, s48, 10
  s_add_u32 s55, s48, 720896
  s_lshr_b32 s48, s60, 1
  s_lshl_b32 s49, s44, 2
  s_add_u32 s61, s48, s49
  s_lshl_b32 s48, s61, 2
  s_add_u32 s48, s48, s59
  s_lshl_b32 s48, s48, 10
  s_and_b32 s62, s60, 1
  s_lshl_b32 s49, s62, 9
  s_add_u32 s48, s48, s49
  s_add_u32 s54, s48, 1048576
  v_lshrrev_b32 v12, 3, v0
  v_and_b32 v10, 7, v0
  v_mul_u32_u24 v8, 3584, v12
  v_lshl_add_u32 v8, v10, 4, v8
  v_lshlrev_b32 v12, 10, v12
  v_lshl_add_u32 v12, v10, 4, v12
  v_add_u32 v18, s55, v11
  v_add_u32 v11, s54, v11
  s_cmp_eq_u32 s44, 7
  s_cbranch_scc1 L_gu_done
  s_mov_b32 s38, 1835008
  s_cmp_eq_u32 s62, 0
  s_cselect_b32 s36, s16, s18
  s_cselect_b32 s37, s17, s19
  s_mul_i32 s48, s59, 458752
  s_lshl_b32 s49, s61, 7
  s_add_u32 s48, s48, s49
  s_mov_b32 m0, 131072
  s_nop 0
  buffer_load_dwordx4 v8, s[36:39], s48 offen nt lds
  s_mov_b32 m0, 132096
  s_add_u32 s48, s48, 28672
  buffer_load_dwordx4 v8, s[36:39], s48 offen nt lds
  s_mov_b32 m0, 133120
  s_add_u32 s48, s48, 28672
  buffer_load_dwordx4 v8, s[36:39], s48 offen nt lds
  s_mov_b32 m0, 134144
  s_add_u32 s48, s48, 28672
  buffer_load_dwordx4 v8, s[36:39], s48 offen nt lds
  s_mov_b32 m0, 135168
  s_add_u32 s48, s48, 28672
  buffer_load_dwordx4 v8, s[36:39], s48 offen nt lds
  s_mov_b32 m0, 136192
  s_add_u32 s48, s48, 28672
  buffer_load_dwordx4 v8, s[36:39], s48 offen nt lds
  s_mov_b32 m0, 137216
  s_add_u32 s48, s48, 28672
  buffer_load_dwordx4 v8, s[36:39], s48 offen nt lds
  s_mov_b32 m0, 138240
  s_add_u32 s48, s48, 28672
  buffer_load_dwordx4 v8, s[36:39], s48 offen nt lds
  s_mov_b32 m0, 139264
  s_add_u32 s48, s48, 28672
  buffer_load_dwordx4 v8, s[36:39], s48 offen nt lds
  s_mov_b32 m0, 140288
  s_add_u32 s48, s48, 28672
  buffer_load_dwordx4 v8, s[36:39], s48 offen nt lds
  s_mov_b32 m0, 141312
  s_add_u32 s48, s48, 28672
  buffer_load_dwordx4 v8, s[36:39], s48 offen nt lds
  s_mov_b32 m0, 142336
  s_add_u32 s48, s48, 28672
  buffer_load_dwordx4 v8, s[36:39], s48 offen nt lds
  s_mov_b32 m0, 143360
  s_add_u32 s48, s48, 28672
  buffer_load_dwordx4 v8, s[36:39], s48 offen nt lds
  s_mov_b32 m0, 144384
  s_add_u32 s48, s48, 28672
  buffer_load_dwordx4 v8, s[36:39], s48 offen nt lds
  s_mov_b32 m0, 145408
  s_add_u32 s48, s48, 28672
  buffer_load_dwordx4 v8, s[36:39], s48 offen nt lds
  s_mov_b32 m0, 146432
  s_add_u32 s48, s48, 28672
  buffer_load_dwordx4 v8, s[36:39], s48 offen nt lds
  s_waitcnt vmcnt(0)
  ds_read_b64_tr_b16 v[128:129], v13 offset:0
  ds_read_b64_tr_b16 v[130:131], v13 offset:2048
  ds_read_b64_tr_b16 v[132:133], v13 offset:32
  ds_read_b64_tr_b16 v[134:135], v13 offset:2080
  ds_read_b64_tr_b16 v[136:137], v13 offset:64
  ds_read_b64_tr_b16 v[138:139], v13 offset:2112
  ds_read_b64_tr_b16 v[140:141], v13 offset:96
  ds_read_b64_tr_b16 v[142:143], v13 offset:2144
  ds_read_b64_tr_b16 v[144:145], v13 offset:4096
  ds_read_b64_tr_b16 v[146:147], v13 offset:6144
  ds_read_b64_tr_b16 v[148:149], v13 offset:4128
  ds_read_b64_tr_b16 v[150:151], v13 offset:6176
  ds_read_b64_tr_b16 v[152:153], v13 offset:4160
  ds_read_b64_tr_b16 v[154:155], v13 offset:6208
  ds_read_b64_tr_b16 v[156:157], v13 offset:4192
  ds_read_b64_tr_b16 v[158:159], v13 offset:6240
  ds_read_b64_tr_b16 v[160:161], v13 offset:8192
  ds_read_b64_tr_b16 v[162:163], v13 offset:10240
  ds_read_b64_tr_b16 v[164:165], v13 offset:8224
  ds_read_b64_tr_b16 v[166:167], v13 offset:10272
  ds_read_b64_tr_b16 v[168:169], v13 offset:8256
  ds_read_b64_tr_b16 v[170:171], v13 offset:10304
  ds_read_b64_tr_b16 v[172:173], v13 offset:8288
  ds_read_b64_tr_b16 v[174:175], v13 offset:10336
  ds_read_b64_tr_b16 v[176:177], v13 offset:12288
  ds_read_b64_tr_b16 v[178:179], v13 offset:14336
  ds_read_b64_tr_b16 v[180:181], v13 offset:12320
  ds_read_b64_tr_b16 v[182:183], v13 offset:14368
  ds_read_b64_tr_b16 v[184:185], v13 offset:12352
  ds_read_b64_tr_b16 v[186:187], v13 offset:14400
  ds_read_b64_tr_b16 v[188:189], v13 offset:12384
  ds_read_b64_tr_b16 v[190:191], v13 offset:14432
  s_waitcnt lgkmcnt(0)
  v_mfma_f32_16x16x32_bf16 v[48:51], v[128:131], v[32:35], 0
  v_mfma_f32_16x16x32_bf16 v[52:55], v[132:135], v[32:35], 0
  v_mfma_f32_16x16x32_bf16 v[56:59], v[136:139], v[32:35], 0
  v_mfma_f32_16x16x32_bf16 v[60:63], v[140:143], v[32:35], 0
  v_mfma_f32_16x16x32_bf16 v[48:51], v[144:147], v[36:39], v[48:51]
  v_mfma_f32_16x16x32_bf16 v[52:55], v[148:151], v[36:39], v[52:55]
  v_mfma_f32_16x16x32_bf16 v[56:59], v[152:155], v[36:39], v[56:59]
  v_mfma_f32_16x16x32_bf16 v[60:63], v[156:159], v[36:39], v[60:63]
  v_mfma_f32_16x16x32_bf16 v[48:51], v[160:163], v[40:43], v[48:51]
  v_mfma_f32_16x16x32_bf16 v[52:55], v[164:167], v[40:43], v[52:55]
  v_mfma_f32_16x16x32_bf16 v[56:59], v[168:171], v[40:43], v[56:59]
  v_mfma_f32_16x16x32_bf16 v[60:63], v[172:175], v[40:43], v[60:63]
  v_mfma_f32_16x16x32_bf16 v[48:51], v[176:179], v[44:47], v[48:51]
  v_mfma_f32_16x16x32_bf16 v[52:55], v[180:183], v[44:47], v[52:55]
  v_mfma_f32_16x16x32_bf16 v[56:59], v[184:187], v[44:47], v[56:59]
  v_mfma_f32_16x16x32_bf16 v[60:63], v[188:191], v[44:47], v[60:63]
  s_nop 5
  v_cndmask_b32 v48, v48, v52, s[72:73]
  v_cndmask_b32 v49, v49, v53, s[72:73]
  v_cndmask_b32 v50, v50, v54, s[72:73]
  v_cndmask_b32 v51, v51, v55, s[72:73]
  v_cndmask_b32 v48, v48, v56, s[74:75]
  v_cndmask_b32 v49, v49, v57, s[74:75]
  v_cndmask_b32 v50, v50, v58, s[74:75]
  v_cndmask_b32 v51, v51, v59, s[74:75]
  v_cndmask_b32 v48, v48, v60, s[76:77]
  v_cndmask_b32 v49, v49, v61, s[76:77]
  v_cndmask_b32 v50, v50, v62, s[76:77]
  v_cndmask_b32 v51, v51, v63, s[76:77]
  v_min_u32 v48, -2, v48
  v_min_u32 v49, -2, v49
  v_min_u32 v50, -2, v50
  v_min_u32 v51, -2, v51
  s_mov_b32 exec_lo, 0x00ff00ff
  s_mov_b32 exec_hi, 0x00ff00ff
  global_store_dwordx4 v11, v[48:51], s[26:27] sc1
  s_mov_b64 exec, -1
L_gu_done:
  s_lshl_b32 s48, s40, 14
  s_add_u32 s48, s48, 1576960
  v_add_u32 v9, s48, v1
  v_add_u32 v10, 8192, v9
  s_mov_b32 s57, 50000
  s_mov_b64 s[28:29], -1
  s_mov_b64 s[30:31], -1
  s_mov_b64 s[32:33], -1
  s_mov_b64 s[34:35], -1
  s_mov_b64 s[64:65], -1
  s_mov_b64 s[66:67], -1
  s_mov_b64 s[68:69], -1
  s_mov_b64 s[70:71], -1
L_q_poll:
  s_mov_b64 exec, s[28:29]
  s_cbranch_execz L_q_skip0
  global_load_dwordx4 v[64:67], v9, s[26:27] offset:-4096 sc1
  global_load_dwordx4 v[68:71], v9, s[26:27] offset:-3072 sc1
L_q_skip0:
  s_mov_b64 exec, s[30:31]
  s_cbranch_execz L_q_skip1
  global_load_dwordx4 v[72:75], v9, s[26:27] offset:-2048 sc1
  global_load_dwordx4 v[76:79], v9, s[26:27] offset:-1024 sc1
L_q_skip1:
  s_mov_b64 exec, s[32:33]
  s_cbranch_execz L_q_skip2
  global_load_dwordx4 v[80:83], v9, s[26:27] offset:0 sc1
  global_load_dwordx4 v[84:87], v9, s[26:27] offset:1024 sc1
L_q_skip2:
  s_mov_b64 exec, s[34:35]
  s_cbranch_execz L_q_skip3
  global_load_dwordx4 v[88:91], v9, s[26:27] offset:2048 sc1
  global_load_dwordx4 v[92:95], v9, s[26:27] offset:3072 sc1
L_q_skip3:
  s_mov_b64 exec, s[64:65]
  s_cbranch_execz L_q_skip4
  global_load_dwordx4 v[96:99], v10, s[26:27] offset:-4096 sc1
  global_load_dwordx4 v[100:103], v10, s[26:27] offset:-3072 sc1
L_q_skip4:
  s_mov_b64 exec, s[66:67]
  s_cbranch_execz L_q_skip5
  global_load_dwordx4 v[104:107], v10, s[26:27] offset:-2048 sc1
  global_load_dwordx4 v[108:111], v10, s[26:27] offset:-1024 sc1
L_q_skip5:
  s_mov_b64 exec, s[68:69]
  s_cbranch_execz L_q_skip6
  global_load_dwordx4 v[112:115], v10, s[26:27] offset:0 sc1
  global_load_dwordx4 v[116:119], v10, s[26:27] offset:1024 sc1
L_q_skip6:
  s_mov_b64 exec, s[70:71]
  s_cbranch_execz L_q_skip7
  global_load_dwordx4 v[120:123], v10, s[26:27] offset:2048 sc1
  global_load_dwordx4 v[124:127], v10, s[26:27] offset:3072 sc1
L_q_skip7:
  s_mov_b64 exec, -1
  s_waitcnt vmcnt(0)
  v_xor_b32 v32, v65, v24
  v_xor_b32 v33, v73, v24
  v_xor_b32 v34, v81, v24
  v_xor_b32 v35, v89, v24
  v_xor_b32 v36, v97, v24
  v_xor_b32 v37, v105, v24
  v_xor_b32 v38, v113, v24
  v_xor_b32 v39, v121, v24
  v_bitop3_b32 v32, v67, v25, v32 bitop3:0xbe
  v_bitop3_b32 v33, v75, v25, v33 bitop3:0xbe
  v_bitop3_b32 v34, v83, v25, v34 bitop3:0xbe
  v_bitop3_b32 v35, v91, v25, v35 bitop3:0xbe
  v_bitop3_b32 v36, v99, v25, v36 bitop3:0xbe
  v_bitop3_b32 v37, v107, v25, v37 bitop3:0xbe
  v_bitop3_b32 v38, v115, v25, v38 bitop3:0xbe
  v_bitop3_b32 v39, v123, v25, v39 bitop3:0xbe
  v_bitop3_b32 v32, v69, v24, v32 bitop3:0xbe
  v_bitop3_b32 v33, v77, v24, v33 bitop3:0xbe
  v_bitop3_b32 v34, v85, v24, v34 bitop3:0xbe
  v_bitop3_b32 v35, v93, v24, v35 bitop3:0xbe
  v_bitop3_b32 v36, v101, v24, v36 bitop3:0xbe
  v_bitop3_b32 v37, v109, v24, v37 bitop3:0xbe
  v_bitop3_b32 v38, v117, v24, v38 bitop3:0xbe
  v_bitop3_b32 v39, v125, v24, v39 bitop3:0xbe
  v_bitop3_b32 v32, v71, v25, v32 bitop3:0xbe
  v_bitop3_b32 v33, v79, v25, v33 bitop3:0xbe
  v_bitop3_b32 v34, v87, v25, v34 bitop3:0xbe
  v_bitop3_b32 v35, v95, v25, v35 bitop3:0xbe
  v_bitop3_b32 v36, v103, v25, v36 bitop3:0xbe
  v_bitop3_b32 v37, v111, v25, v37 bitop3:0xbe
  v_bitop3_b32 v38, v119, v25, v38 bitop3:0xbe
  v_bitop3_b32 v39, v127, v25, v39 bitop3:0xbe
  v_cmp_ne_u32 s[28:29], 0, v32
  v_cmp_ne_u32 s[30:31], 0, v33
  v_cmp_ne_u32 s[32:33], 0, v34
  v_cmp_ne_u32 s[34:35], 0, v35
  v_cmp_ne_u32 s[64:65], 0, v36
  v_cmp_ne_u32 s[66:67], 0, v37
  v_cmp_ne_u32 s[68:69], 0, v38
  v_cmp_ne_u32 s[70:71], 0, v39
  v_or3_b32 v32, v32, v33, v34
  v_or3_b32 v35, v35, v36, v37
  v_or3_b32 v32, v32, v38, v39
  v_or_b32 v32, v32, v35
  v_cmp_ne_u32 vcc, 0, v32
  s_cbranch_vccz L_q_done
  s_sub_u32 s57, s57, 1
  s_cmp_eq_u32 s57, 0
  s_cbranch_scc1 L_q_done
  s_sleep 2
  s_branch L_q_poll
L_q_done:
  v_add_f32 v64, v64, v96
  v_add_f32 v66, v66, v98
  v_add_f32 v68, v68, v100
  v_add_f32 v70, v70, v102
  v_add_f32 v72, v72, v104
  v_add_f32 v74, v74, v106
  v_add_f32 v76, v76, v108
  v_add_f32 v78, v78, v110
  v_add_f32 v80, v80, v112
  v_add_f32 v82, v82, v114
  v_add_f32 v84, v84, v116
  v_add_f32 v86, v86, v118
  v_add_f32 v88, v88, v120
  v_add_f32 v90, v90, v122
  v_add_f32 v92, v92, v124
  v_add_f32 v94, v94, v126
  v_add_f32 v64, v64, v80
  v_add_f32 v66, v66, v82
  v_add_f32 v68, v68, v84
  v_add_f32 v70, v70, v86
  v_add_f32 v72, v72, v88
  v_add_f32 v74, v74, v90
  v_add_f32 v76, v76, v92
  v_add_f32 v78, v78, v94
  v_lshlrev_b32 v8, 2, v0
  v_add_u32 v8, 161792, v8
  v_cvt_pk_bf16_f32 v64, v64, v66
  ds_write_b32 v8, v64 offset:0
  v_cvt_pk_bf16_f32 v68, v68, v70
  ds_write_b32 v8, v68 offset:256
  v_cvt_pk_bf16_f32 v72, v72, v74
  ds_write_b32 v8, v72 offset:512
  v_cvt_pk_bf16_f32 v76, v76, v78
  ds_write_b32 v8, v76 offset:768
  v_mov_b32 v27, 1
  s_waitcnt lgkmcnt(0)
  ds_write_b32 v5, v27 offset:12
  s_lshl_b32 s50, s44, 8
  s_add_u32 s50, s50, 8192
  v_and_b32 v9, 31, v0
  v_lshlrev_b32 v9, 3, v9
  v_add_u32 v9, s50, v9
  s_mov_b32 s57, 50000
L_r_poll:
  global_load_dwordx2 v[32:33], v9, s[26:27] sc1
  s_waitcnt vmcnt(0)
  v_xor_b32 v32, v32, v20
  v_xor_b32 v33, v33, v21
  v_and_b32 v34, 0xffffff00, v33
  v_or_b32 v32, v32, v34
  v_cmp_ne_u32 vcc, 0, v32
  s_cbranch_vccz L_r_done
  s_sub_u32 s57, s57, 1
  s_cmp_eq_u32 s57, 0
  s_cbranch_scc1 L_r_done
  s_sleep 8
  s_branch L_r_poll
L_r_done:
  v_cmp_ne_u32 vcc, 0, v33
  s_nop 0
  s_cmp_eq_u64 vcc, 0
  s_cselect_b32 s62, 1, 0
  s_lshr_b32 s48, s47, 4
  s_lshl_b32 s48, s48, 10
  s_lshl_b32 s49, s44, 7
  s_add_u32 s48, s48, s49
  s_and_b32 s49, s47, 15
  s_lshl_b32 s49, s49, 3
  s_add_u32 s58, s48, s49
  v_mov_b32 v15, s58
  global_load_dwordx2 v[16:17], v15, s[4:5]
  s_lshl_b32 s48, s47, 12
  s_add_u32 s48, s48, 1048576
  v_add_u32 v9, s48, v1
  s_mov_b32 s57, 50000
  v_mov_b32 v52, 0
  v_mov_b32 v53, 0
  s_cmp_eq_u32 s41, 7
  s_cbranch_scc1 L_noh
L_g_poll:
  global_load_dwordx4 v[64:67], v9, s[26:27] offset:0 sc1
  global_load_dwordx4 v[68:71], v9, s[26:27] offset:1024 sc1
  global_load_dwordx4 v[72:75], v9, s[26:27] offset:2048 sc1
  global_load_dwordx4 v[76:79], v9, s[26:27] offset:3072 sc1
  s_waitcnt vmcnt(0)
  v_mov_b32 v10, 0
  v_max3_u32 v10, v10, v64, v65
  v_max3_u32 v10, v10, v66, v67
  v_max3_u32 v10, v10, v68, v69
  v_max3_u32 v10, v10, v70, v71
  v_max3_u32 v10, v10, v72, v73
  v_max3_u32 v10, v10, v74, v75
  v_max3_u32 v10, v10, v76, v77
  v_max3_u32 v10, v10, v78, v79
  v_cmp_eq_u32 vcc, -1, v10
  s_cbranch_vccz L_g_done
  s_sub_u32 s57, s57, 1
  s_cmp_eq_u32 s57, 0
  s_cbranch_scc1 L_g_done
  s_sleep 8
  s_branch L_g_poll
L_g_done:
  v_add_f32 v64, v64, v72
  v_add_f32 v65, v65, v73
  v_add_f32 v66, v66, v74
  v_add_f32 v67, v67, v75
  v_add_f32 v68, v68, v76
  v_add_f32 v69, v69, v77
  v_add_f32 v70, v70, v78
  v_add_f32 v71, v71, v79
  v_add_f32 v64, v64, v68
  v_add_f32 v65, v65, v69
  v_add_f32 v66, v66, v70
  v_add_f32 v67, v67, v71
  v_cvt_pk_bf16_f32 v52, v64, v65
  v_cvt_pk_bf16_f32 v53, v66, v67
  v_mov_b32 v54, v52
  v_mov_b32 v55, v53
  s_nop 0
  v_permlane32_swap_b32 v52, v54
  v_permlane32_swap_b32 v53, v55
  s_mov_b32 s48, 0x3d372713
  s_mov_b32 s49, 0xc0135761
  v_lshlrev_b32 v32, 16, v52
  v_and_b32 v33, s53, v52
  v_lshlrev_b32 v36, 16, v54
  v_and_b32 v37, s53, v54
  v_lshlrev_b32 v34, 16, v53
  v_and_b32 v35, s53, v53
  v_lshlrev_b32 v38, 16, v55
  v_and_b32 v39, s53, v55
  v_mul_f32 v40, v32, v32
  v_mul_f32 v41, v33, v33
  v_mul_f32 v42, v34, v34
  v_mul_f32 v43, v35, v35
  v_fma_f32 v40, v40, s48, 1.0
  v_fma_f32 v41, v41, s48, 1.0
  v_fma_f32 v42, v42, s48, 1.0
  v_fma_f32 v43, v43, s48, 1.0
  v_mul_f32 v40, v40, v32
  v_mul_f32 v41, v41, v33
  v_mul_f32 v42, v42, v34
  v_mul_f32 v43, v43, v35
  v_mul_f32 v40, s49, v40
  v_mul_f32 v41, s49, v41
  v_mul_f32 v42, s49, v42
  v_mul_f32 v43, s49, v43
  v_exp_f32 v40, v40
  v_exp_f32 v41, v41
  v_exp_f32 v42, v42
  v_exp_f32 v43, v43
  v_add_f32 v40, 1.0, v40
  v_add_f32 v41, 1.0, v41
  v_add_f32 v42, 1.0, v42
  v_add_f32 v43, 1.0, v43
  v_rcp_f32 v40, v40
  v_rcp_f32 v41, v41
  v_rcp_f32 v42, v42
  v_rcp_f32 v43, v43
  v_mul_f32 v40, v40, v32
  v_mul_f32 v41, v41, v33
  v_mul_f32 v42, v42, v34
  v_mul_f32 v43, v43, v35
  v_cvt_pk_bf16_f32 v52, v40, v41
  v_cvt_pk_bf16_f32 v53, v42, v43
  v_lshlrev_b32 v40, 16, v52
  v_and_b32 v41, s53, v52
  v_lshlrev_b32 v42, 16, v53
  v_and_b32 v43, s53, v53
  v_mul_f32 v40, v40, v36
  v_mul_f32 v41, v41, v37
  v_mul_f32 v42, v42, v38
  v_mul_f32 v43, v43, v39
  v_cvt_pk_bf16_f32 v52, v40, v41
  v_cvt_pk_bf16_f32 v53, v42, v43
L_noh:
  s_waitcnt vmcnt(0)
  v_lshlrev_b32 v8, 3, v0
  v_add_u32 v8, 162816, v8
  ds_write_b64 v8, v[52:53]
  v_lshlrev_b32 v9, 7, v6
  v_lshl_add_u32 v9, v2, 3, v9
  v_add_u32 v9, 162816, v9
  s_waitcnt lgkmcnt(0)
  ds_read2_b64 v[64:67], v9 offset0:0 offset1:4
  ds_read2_b64 v[68:71], v9 offset0:8 offset1:12
  s_lshl_b32 s48, s44, 15
  s_lshl_b32 s49, s47, 4
  s_add_u32 s48, s48, s49
  s_add_u32 s48, s48, 720896
  v_and_b32 v19, 31, v0
  v_lshlrev_b32 v19, 10, v19
  v_and_b32 v10, 32, v0
  v_lshl_add_u32 v19, v10, 4, v19
  v_add_u32 v19, s48, v19
  v_lshlrev_b32 v9, 8, v6
  v_lshl_add_u32 v9, v2, 3, v9
  v_add_u32 v9, 162816, v9
  v_and_b32 v10, 1, v2
  v_cmp_eq_u32 vcc, 1, v10
  v_lshl_add_u32 v15, v10, 2, v15
  s_nop 0
  v_cndmask_b32 v16, v16, v17, vcc
  v_lshlrev_b32 v28, 16, v16
  v_and_b32 v29, s53, v16
  s_mov_b32 s63, 0xbfb8aa3b
  v_mov_b64 v[98:99], v[24:25]
  v_mov_b32 v92, 0
  v_mov_b32 v93, 0
  s_waitcnt lgkmcnt(0)
  s_mov_b64 s[28:29], 0
  s_mov_b64 s[30:31], 0
  s_mov_b64 s[32:33], 0
  s_mov_b64 s[34:35], 0
  s_mov_b64 vcc, 0
  s_mov_b64 exec, 0
  s_branch L_fin
L_dry_ret:
  s_mov_b64 exec, -1
  s_mov_b64 s[28:29], 1
  s_mov_b32 s30, 0x00ff00ff
  s_mov_b32 s31, 0x00ff00ff
  s_mov_b64 s[32:33], -1
  s_mov_b64 s[34:35], 0x10001
  s_mov_b32 s57, 1000000
L_tot:
  ds_read2_b32 v[10:11], v5 offset0:1 offset1:2
  s_waitcnt lgkmcnt(0)
  v_readfirstlane_b32 s56, v11
  v_readfirstlane_b32 s50, v10
  s_nop 0
  s_add_u32 s50, s50, 1
  s_cmp_ge_u32 s50, s56
  s_cbranch_scc1 L_tot_done
  s_sub_u32 s57, s57, 1
  s_cmp_lg_u32 s57, 0
  s_sleep 2
  s_cbranch_scc1 L_tot
L_tot_done:
  s_mov_b32 s38, 1835008
  s_mov_b32 s36, s20
  s_mov_b32 s37, s21
  s_lshl_b32 s48, s47, 16
  s_lshl_b32 s49, s44, 7
  s_add_u32 s48, s48, s49
  s_mov_b32 m0, 147456
  s_nop 0
  buffer_load_dwordx4 v12, s[36:39], s48 offen nt lds
  s_mov_b32 m0, 148480
  s_add_u32 s48, s48, 8192
  buffer_load_dwordx4 v12, s[36:39], s48 offen nt lds
  s_mov_b32 m0, 149504
  s_add_u32 s48, s48, 8192
  buffer_load_dwordx4 v12, s[36:39], s48 offen nt lds
  s_mov_b32 m0, 150528
  s_add_u32 s48, s48, 8192
  buffer_load_dwordx4 v12, s[36:39], s48 offen nt lds
  s_mov_b32 m0, 151552
  s_add_u32 s48, s48, 8192
  buffer_load_dwordx4 v12, s[36:39], s48 offen nt lds
  s_mov_b32 m0, 152576
  s_add_u32 s48, s48, 8192
  buffer_load_dwordx4 v12, s[36:39], s48 offen nt lds
  s_mov_b32 m0, 153600
  s_add_u32 s48, s48, 8192
  buffer_load_dwordx4 v12, s[36:39], s48 offen nt lds
  s_mov_b32 m0, 154624
  s_add_u32 s48, s48, 8192
  buffer_load_dwordx4 v12, s[36:39], s48 offen nt lds
  s_mov_b32 s38, 0x400000
  s_mov_b32 s36, s12
  s_mov_b32 s37, s13
  s_lshl_b32 s48, s47, 17
  s_add_u32 s48, s48, s49
  s_mov_b32 m0, 131072
  s_nop 0
  buffer_load_dwordx4 v12, s[36:39], s48 offen nt lds
  s_mov_b32 m0, 132096
  s_add_u32 s48, s48, 8192
  buffer_load_dwordx4 v12, s[36:39], s48 offen nt lds
  s_mov_b32 m0, 133120
  s_add_u32 s48, s48, 8192
  buffer_load_dwordx4 v12, s[36:39], s48 offen nt lds
  s_mov_b32 m0, 134144
  s_add_u32 s48, s48, 8192
  buffer_load_dwordx4 v12, s[36:39], s48 offen nt lds
  s_mov_b32 m0, 135168
  s_add_u32 s48, s48, 8192
  buffer_load_dwordx4 v12, s[36:39], s48 offen nt lds
  s_mov_b32 m0, 136192
  s_add_u32 s48, s48, 8192
  buffer_load_dwordx4 v12, s[36:39], s48 offen nt lds
  s_mov_b32 m0, 137216
  s_add_u32 s48, s48, 8192
  buffer_load_dwordx4 v12, s[36:39], s48 offen nt lds
  s_mov_b32 m0, 138240
  s_add_u32 s48, s48, 8192
  buffer_load_dwordx4 v12, s[36:39], s48 offen nt lds
  s_mov_b32 m0, 139264
  s_add_u32 s48, s48, 8192
  buffer_load_dwordx4 v12, s[36:39], s48 offen nt lds
  s_mov_b32 m0, 140288
  s_add_u32 s48, s48, 8192
  buffer_load_dwordx4 v12, s[36:39], s48 offen nt lds
  s_mov_b32 m0, 141312
  s_add_u32 s48, s48, 8192
  buffer_load_dwordx4 v12, s[36:39], s48 offen nt lds
  s_mov_b32 m0, 142336
  s_add_u32 s48, s48, 8192
  buffer_load_dwordx4 v12, s[36:39], s48 offen nt lds
  s_mov_b32 m0, 143360
  s_add_u32 s48, s48, 8192
  buffer_load_dwordx4 v12, s[36:39], s48 offen nt lds
  s_mov_b32 m0, 144384
  s_add_u32 s48, s48, 8192
  buffer_load_dwordx4 v12, s[36:39], s48 offen nt lds
  s_mov_b32 m0, 145408
  s_add_u32 s48, s48, 8192
  buffer_load_dwordx4 v12, s[36:39], s48 offen nt lds
  s_mov_b32 m0, 146432
  s_add_u32 s48, s48, 8192
  buffer_load_dwordx4 v12, s[36:39], s48 offen nt lds
  s_barrier
L_dry_aux:
  s_waitcnt vmcnt(16)
  ds_read_b64_tr_b16 v[192:193], v14 offset:0
  ds_read_b64_tr_b16 v[194:195], v14 offset:2048
  ds_read_b64_tr_b16 v[196:197], v14 offset:32
  ds_read_b64_tr_b16 v[198:199], v14 offset:2080
  ds_read_b64_tr_b16 v[200:201], v14 offset:64
  ds_read_b64_tr_b16 v[202:203], v14 offset:2112
  ds_read_b64_tr_b16 v[204:205], v14 offset:96
  ds_read_b64_tr_b16 v[206:207], v14 offset:2144
  ds_read_b64_tr_b16 v[208:209], v14 offset:4096
  ds_read_b64_tr_b16 v[210:211], v14 offset:6144
  ds_read_b64_tr_b16 v[212:213], v14 offset:4128
  ds_read_b64_tr_b16 v[214:215], v14 offset:6176
  ds_read_b64_tr_b16 v[216:217], v14 offset:4160
  ds_read_b64_tr_b16 v[218:219], v14 offset:6208
  ds_read_b64_tr_b16 v[220:221], v14 offset:4192
  ds_read_b64_tr_b16 v[222:223], v14 offset:6240
  s_waitcnt lgkmcnt(0)
  v_mfma_f32_16x16x32_bf16 v[48:51], v[192:195], v[64:67], 0
  v_mfma_f32_16x16x32_bf16 v[52:55], v[196:199], v[64:67], 0
  v_mfma_f32_16x16x32_bf16 v[56:59], v[200:203], v[64:67], 0
  v_mfma_f32_16x16x32_bf16 v[60:63], v[204:207], v[64:67], 0
  v_mfma_f32_16x16x32_bf16 v[48:51], v[208:211], v[68:71], v[48:51]
  v_mfma_f32_16x16x32_bf16 v[52:55], v[212:215], v[68:71], v[52:55]
  v_mfma_f32_16x16x32_bf16 v[56:59], v[216:219], v[68:71], v[56:59]
  v_mfma_f32_16x16x32_bf16 v[60:63], v[220:223], v[68:71], v[60:63]
  s_waitcnt vmcnt(0)
  ds_read_b64_tr_b16 v[128:129], v13 offset:0
  ds_read_b64_tr_b16 v[130:131], v13 offset:2048
  ds_read_b64_tr_b16 v[132:133], v13 offset:32
  ds_read_b64_tr_b16 v[134:135], v13 offset:2080
  ds_read_b64_tr_b16 v[136:137], v13 offset:64
  ds_read_b64_tr_b16 v[138:139], v13 offset:2112
  ds_read_b64_tr_b16 v[140:141], v13 offset:96
  ds_read_b64_tr_b16 v[142:143], v13 offset:2144
  ds_read_b64_tr_b16 v[144:145], v13 offset:4096
  ds_read_b64_tr_b16 v[146:147], v13 offset:6144
  ds_read_b64_tr_b16 v[148:149], v13 offset:4128
  ds_read_b64_tr_b16 v[150:151], v13 offset:6176
  ds_read_b64_tr_b16 v[152:153], v13 offset:4160
  ds_read_b64_tr_b16 v[154:155], v13 offset:6208
  ds_read_b64_tr_b16 v[156:157], v13 offset:4192
  ds_read_b64_tr_b16 v[158:159], v13 offset:6240
  ds_read_b64_tr_b16 v[160:161], v13 offset:8192
  ds_read_b64_tr_b16 v[162:163], v13 offset:10240
  ds_read_b64_tr_b16 v[164:165], v13 offset:8224
  ds_read_b64_tr_b16 v[166:167], v13 offset:10272
  ds_read_b64_tr_b16 v[168:169], v13 offset:8256
  ds_read_b64_tr_b16 v[170:171], v13 offset:10304
  ds_read_b64_tr_b16 v[172:173], v13 offset:8288
  ds_read_b64_tr_b16 v[174:175], v13 offset:10336
  ds_read_b64_tr_b16 v[176:177], v13 offset:12288
  ds_read_b64_tr_b16 v[178:179], v13 offset:14336
  ds_read_b64_tr_b16 v[180:181], v13 offset:12320
  ds_read_b64_tr_b16 v[182:183], v13 offset:14368
  ds_read_b64_tr_b16 v[184:185], v13 offset:12352
  ds_read_b64_tr_b16 v[186:187], v13 offset:14400
  ds_read_b64_tr_b16 v[188:189], v13 offset:12384
  ds_read_b64_tr_b16 v[190:191], v13 offset:14432
  v_cndmask_b32 v48, v48, v52, s[72:73]
  v_cndmask_b32 v49, v49, v53, s[72:73]
  v_cndmask_b32 v50, v50, v54, s[72:73]
  v_cndmask_b32 v51, v51, v55, s[72:73]
  v_cndmask_b32 v48, v48, v56, s[74:75]
  v_cndmask_b32 v49, v49, v57, s[74:75]
  v_cndmask_b32 v50, v50, v58, s[74:75]
  v_cndmask_b32 v51, v51, v59, s[74:75]
  v_cndmask_b32 v48, v48, v60, s[76:77]
  v_cndmask_b32 v49, v49, v61, s[76:77]
  v_cndmask_b32 v50, v50, v62, s[76:77]
  v_cndmask_b32 v51, v51, v63, s[76:77]
  v_min_u32 v48, -2, v48
  v_min_u32 v49, -2, v49
  v_min_u32 v50, -2, v50
  v_min_u32 v51, -2, v51
  s_cmp_eq_u32 s62, 1
  s_mov_b64 exec, s[30:31]
  s_cbranch_execz L_nosy512
  s_cbranch_scc1 L_locsy512
  global_store_dwordx4 v18, v[48:51], s[26:27] offset:512 sc1
  s_branch L_nosy512
L_locsy512:
  global_store_dwordx4 v18, v[48:51], s[26:27] offset:512
L_nosy512:
  s_mov_b64 exec, s[32:33]
  s_mov_b64 s[64:65], s[32:33]
  s_mov_b32 s57, 50000
  s_waitcnt lgkmcnt(0)
  s_cbranch_execz L_nb3
  s_barrier
L_nb3:
  ds_read2_b64 v[32:35], v9 offset0:0 offset1:4
  ds_read2_b64 v[36:39], v9 offset0:8 offset1:12
  ds_read2_b64 v[40:43], v9 offset0:16 offset1:20
  ds_read2_b64 v[44:47], v9 offset0:24 offset1:28
  s_waitcnt lgkmcnt(3)
  v_mfma_f32_16x16x32_bf16 v[48:51], v[128:131], v[32:35], 0
  v_mfma_f32_16x16x32_bf16 v[52:55], v[132:135], v[32:35], 0
  v_mfma_f32_16x16x32_bf16 v[56:59], v[136:139], v[32:35], 0
  v_mfma_f32_16x16x32_bf16 v[60:63], v[140:143], v[32:35], 0
  s_waitcnt lgkmcnt(2)
  v_mfma_f32_16x16x32_bf16 v[48:51], v[144:147], v[36:39], v[48:51]
  v_mfma_f32_16x16x32_bf16 v[52:55], v[148:151], v[36:39], v[52:55]
  v_mfma_f32_16x16x32_bf16 v[56:59], v[152:155], v[36:39], v[56:59]
  v_mfma_f32_16x16x32_bf16 v[60:63], v[156:159], v[36:39], v[60:63]
  s_waitcnt lgkmcnt(1)
  v_mfma_f32_16x16x32_bf16 v[48:51], v[160:163], v[40:43], v[48:51]
  v_mfma_f32_16x16x32_bf16 v[52:55], v[164:167], v[40:43], v[52:55]
  v_mfma_f32_16x16x32_bf16 v[56:59], v[168:171], v[40:43], v[56:59]
  v_mfma_f32_16x16x32_bf16 v[60:63], v[172:175], v[40:43], v[60:63]
  s_waitcnt lgkmcnt(0)
  v_mfma_f32_16x16x32_bf16 v[48:51], v[176:179], v[44:47], v[48:51]
  v_mfma_f32_16x16x32_bf16 v[52:55], v[180:183], v[44:47], v[52:55]
  v_mfma_f32_16x16x32_bf16 v[56:59], v[184:187], v[44:47], v[56:59]
  v_mfma_f32_16x16x32_bf16 v[60:63], v[188:191], v[44:47], v[60:63]
  s_nop 5
  v_cndmask_b32 v48, v48, v52, s[72:73]
  v_cndmask_b32 v49, v49, v53, s[72:73]
  v_cndmask_b32 v50, v50, v54, s[72:73]
  v_cndmask_b32 v51, v51, v55, s[72:73]
  v_cndmask_b32 v48, v48, v56, s[74:75]
  v_cndmask_b32 v49, v49, v57, s[74:75]
  v_cndmask_b32 v50, v50, v58, s[74:75]
  v_cndmask_b32 v51, v51, v59, s[74:75]
  v_cndmask_b32 v48, v48, v60, s[76:77]
  v_cndmask_b32 v49, v49, v61, s[76:77]
  v_cndmask_b32 v50, v50, v62, s[76:77]
  v_cndmask_b32 v51, v51, v63, s[76:77]
  v_min_u32 v48, -2, v48
  v_min_u32 v49, -2, v49
  v_min_u32 v50, -2, v50
  v_min_u32 v51, -2, v51
  s_cmp_eq_u32 s62, 1
  s_mov_b64 exec, s[30:31]
  s_cbranch_execz L_nosy0
  s_cbranch_scc1 L_locsy0
  global_store_dwordx4 v18, v[48:51], s[26:27] offset:0 sc1
  s_branch L_nosy0
L_locsy0:
  global_store_dwordx4 v18, v[48:51], s[26:27] offset:0
L_nosy0:
  s_mov_b64 exec, s[32:33]
L_s_poll:
  s_mov_b64 exec, s[64:65]
  s_cbranch_execz L_s_skip
  global_load_dwordx4 v[32:35], v19, s[26:27] sc1
L_s_skip:
  s_mov_b64 exec, s[32:33]
  s_waitcnt vmcnt(0)
  v_max3_u32 v10, v32, v33, v34
  v_max_u32 v10, v10, v35
  v_cmp_eq_u32 vcc, -1, v10
  s_nop 0
  s_mov_b64 s[64:65], vcc
  s_cbranch_vccz L_s_done
  s_sub_u32 s57, s57, 1
  s_cmp_eq_u32 s57, 0
  s_cbranch_scc1 L_s_done
  s_branch L_s_poll
L_s_done:
  v_mov_b64 v[36:37], v[32:33]
  v_mov_b64 v[38:39], v[34:35]
  s_nop 1
  v_permlane16_swap_b32 v36, v38
  v_permlane16_swap_b32 v37, v39
  v_add_f32 v36, v36, v38
  v_add_f32 v37, v37, v39
  s_nop 0
  v_add_f32_dpp v36, v36, v36 row_ror:8 row_mask:0xf bank_mask:0xf
  v_add_f32_dpp v37, v37, v37 row_ror:8 row_mask:0xf bank_mask:0xf
  s_nop 0
  v_add_f32_dpp v36, v36, v36 row_ror:4 row_mask:0xf bank_mask:0xf
  v_add_f32_dpp v37, v37, v37 row_ror:4 row_mask:0xf bank_mask:0xf
  s_nop 0
  v_add_f32_dpp v36, v36, v36 row_ror:2 row_mask:0xf bank_mask:0xf
  v_add_f32_dpp v37, v37, v37 row_ror:2 row_mask:0xf bank_mask:0xf
  s_nop 0
  v_add_f32_dpp v36, v36, v36 row_ror:1 row_mask:0xf bank_mask:0xf
  v_add_f32_dpp v37, v37, v37 row_ror:1 row_mask:0xf bank_mask:0xf
  v_cvt_pk_bf16_f32 v36, v36, v37
  v_mov_b32 v37, v36
  s_nop 1
  v_permlane32_swap_b32 v36, v37
  v_lshlrev_b32 v38, 16, v37
  v_and_b32 v39, s53, v37
  v_mul_f32 v40, s63, v38
  v_mul_f32 v41, s63, v39
  v_exp_f32 v40, v40
  v_exp_f32 v41, v41
  v_lshlrev_b32 v42, 16, v36
  v_and_b32 v43, s53, v36
  v_add_f32 v40, 1.0, v40
  v_add_f32 v41, 1.0, v41
  v_rcp_f32 v40, v40
  v_rcp_f32 v41, v41
  v_mul_f32 v40, v40, v38
  v_mul_f32 v41, v41, v39
  v_cvt_pk_bf16_f32 v40, v40, v41
  v_and_b32 v41, s53, v40
  v_lshlrev_b32 v40, 16, v40
  v_mul_f32 v42, v42, v40
  v_mul_f32 v43, v43, v41
  v_cvt_pk_bf16_f32 v42, v42, v43
  v_and_b32 v43, s53, v42
  v_lshlrev_b32 v42, 16, v42
  v_add_f32 v42, v42, v28
  v_add_f32 v43, v43, v29
  v_cvt_pk_bf16_f32 v42, v42, v43
  s_mov_b64 exec, s[34:35]
  s_cbranch_execz L_dry_ret
  global_store_dword v15, v42, s[22:23]
  s_cmp_lg_u32 s2, 0
  s_cbranch_scc1 L_noepoch
  s_mov_b64 exec, 1
  global_store_dwordx2 v4, v[98:99], s[26:27]
L_noepoch:
L_end:
  s_endpgm
.section .rodata,"a"
.p2align 6
.amdhsa_kernel recurrent_scan__gqa_block_cached__glu_gated_geglu__decode_kernel
  .amdhsa_next_free_vgpr 256
  .amdhsa_next_free_sgpr 102
  .amdhsa_accum_offset 256
  .amdhsa_float_denorm_mode_32 3
  .amdhsa_group_segment_fixed_size 0
  .amdhsa_kernarg_size 96
  .amdhsa_user_sgpr_count 2
  .amdhsa_user_sgpr_kernarg_segment_ptr 1
  .amdhsa_system_sgpr_workgroup_id_x 1
.end_amdhsa_kernel
```
